```python
import torch

def _softmax(x, axis=-1):
    return torch.softmax(x, dim=axis)
def _gelu(x):
    return torch.nn.functional.gelu(x, approximate="tanh")
def _silu(x):
    return torch.nn.functional.silu(x)
def _sigmoid(x):
    return torch.sigmoid(x)
def _layernorm(x, axis=-1, eps=1e-5):
    m = x.mean(dim=axis, keepdim=True)
    v = x.var(dim=axis, keepdim=True, unbiased=False)
    return (x - m) / torch.sqrt(v + eps)
def _scatter_add(tgt, idx, src, axis=0):
    return tgt.clone().index_add_(axis, idx, src)
def _segment_sum(src, seg, n):
    out = torch.zeros((n,) + src.shape[1:], dtype=src.dtype)
    return out.index_add_(0, seg, src)
def _pad(x, pw):
    flat = tuple(v for pair in reversed(pw) for v in pair)
    return torch.nn.functional.pad(x, flat)

kernel_name = 'sequential_preLN__gqa_block_cached__glu_gated_geglu__decode'

def setup_inputs():

    _w = (lambda a: (lambda t: t.to(torch.bfloat16) if t.is_floating_point() else t)(torch.as_tensor(a)))
    def _A_setup():
        B, Sq, D = 1, 1, 512
        Hq, Hkv, Sk, Dh = 32, 8, 32768, 128
        assert Hq % Hkv == 0, (Hq, Hkv)
        return {
            "x": _w((lambda *s: torch.randn(*s, dtype=torch.bfloat16) * 0.05)(B, Sq, D)),
            "k_cache": _w((lambda *s: torch.randn(*s, dtype=torch.bfloat16) * 3.2)(B, Hkv, Sk, Dh)),
            "v_cache": _w((lambda *s: torch.randn(*s, dtype=torch.bfloat16) * 1.6)(B, Hkv, Sk, Dh)),
            "wq": _w((lambda *s: torch.randn(*s, dtype=torch.bfloat16) * 3.2)(D, Hq * Dh) * (D ** -0.5)),
            "wo": _w((lambda *s: torch.randn(*s, dtype=torch.bfloat16) * 1.6)(Hq * Dh, D) * ((Hq * Dh) ** -0.5)),
        }
    _A_in = _A_setup()

    def _B_setup():
        B, S, Dm, Df = 1, 1, 512, 1792
        return {
            "x": _w((lambda *s: torch.randn(*s, dtype=torch.bfloat16) * 0.05)(B, S, Dm)),
            "w_gate": _w((lambda *s: torch.randn(*s, dtype=torch.bfloat16) * 1.6)(Dm, Df) * (Dm ** -0.5)),
            "w_up": _w((lambda *s: torch.randn(*s, dtype=torch.bfloat16) * 1.6)(Dm, Df) * (Dm ** -0.5)),
            "w_down": _w((lambda *s: torch.randn(*s, dtype=torch.bfloat16) * 1.6)(Df, Dm) * (Df ** -0.5)),
        }
    _B_in = _B_setup()

    return {
        "A_x": _A_in["x"],
        "A_k_cache": _A_in["k_cache"],
        "A_v_cache": _A_in["v_cache"],
        "A_wq": _A_in["wq"],
        "A_wo": _A_in["wo"],
        "B_x": _B_in["x"],
        "B_w_gate": _B_in["w_gate"],
        "B_w_up": _B_in["w_up"],
        "B_w_down": _B_in["w_down"],
    }

def reference(A_x, A_k_cache, A_v_cache, A_wq, A_wo, B_x, B_w_gate, B_w_up, B_w_down):
    def _A_ref(x, k_cache, v_cache, wq, wo):
        B, Sq, D = x.shape
        Hq, Dh = 32, 128
        Hkv = k_cache.shape[1]
        rep = Hq // Hkv
        q = (lambda x, *d: x.permute(*d))((x @ wq).reshape(B, Sq, Hq, Dh), 0, 2, 1, 3)
        k = (lambda x, n, axis: torch.repeat_interleave(x, n, dim=axis))(k_cache, rep, axis=1)
        v = (lambda x, n, axis: torch.repeat_interleave(x, n, dim=axis))(v_cache, rep, axis=1)
        scores = torch.einsum("bhqd,bhkd->bhqk", q, k) * (Dh ** -0.5)
        p = _softmax(scores, axis=-1)
        o = torch.einsum("bhqk,bhkd->bhqd", p, v)
        return (lambda x, *d: x.permute(*d))(o, 0, 2, 1, 3).reshape(B, Sq, Hq * Dh) @ wo

    def _B_ref(x, w_gate, w_up, w_down):
        g = torch.einsum("bsd,df->bsf", x, w_gate)
        u = torch.einsum("bsd,df->bsf", x, w_up)
        h = _gelu(g) * u
        return torch.einsum("bsf,fd->bsd", h, w_down)

    x = A_x
    h = x + _A_ref(_layernorm(x, axis=-1), A_k_cache, A_v_cache, A_wq, A_wo)
    h2 = h + _B_ref(_layernorm(h, axis=-1), B_w_gate, B_w_up, B_w_down)
    return h2
```

```asm
; @launch grid=(256,1,1) block=(576,1,1) lds=156160
.amdgcn_target "amdgcn-amd-amdhsa--gfx950"
.text
.globl sequential_preLN__gqa_block_cached__glu_gated_geglu__decode_kernel
.p2align 8
.type sequential_preLN__gqa_block_cached__glu_gated_geglu__decode_kernel,@function
sequential_preLN__gqa_block_cached__glu_gated_geglu__decode_kernel:
    s_load_dwordx16 s[16:31], s[0:1], 0
    s_load_dwordx8 s[32:39], s[0:1], 64
    s_cmp_ge_u32 s2, 256
    s_cbranch_scc1 L_end
    v_lshrrev_b32 v1, 6, v0
    v_and_b32 v0, 63, v0
    v_readfirstlane_b32 s3, v1
    s_and_b32 s6, s2, 7
    s_lshr_b32 s7, s2, 3
    s_add_u32 s60, s6, 4
    s_and_b32 s60, s60, 7
    v_lshlrev_b32 v9, 4, v0
    s_cmp_eq_u32 s3, 8
    s_cbranch_scc1 L_service
    v_lshrrev_b32 v24, 4, v0
    v_lshlrev_b32 v25, 6, v24
    v_xor_b32 v1, v9, v25
    v_xor_b32 v2, 16, v1
    v_xor_b32 v3, 32, v1
    v_xor_b32 v4, 48, v1
    s_lshl_b32 s10, s6, 23
    s_lshl_b32 s11, s3, 12
    s_add_u32 s10, s10, s11
    s_lshl_b32 s11, s7, 18
    s_add_u32 s10, s10, s11
    s_lshr_b32 s11, s7, 2
    s_lshl_b32 s11, s11, 15
    s_add_u32 s10, s10, s11
    s_mov_b32 s11, s10
    s_mul_i32 s56, s3, 12288
    s_add_u32 s56, s56, 57856
    s_mov_b32 s42, 0x4000000
    s_mov_b32 s43, 0x20000
    s_mov_b32 m0, s56
    s_waitcnt lgkmcnt(0)
    s_mov_b32 s40, s18
    s_and_b32 s41, s19, 0xffff
    buffer_load_dwordx4 v1, s[40:43], s10 offen offset:0 nt lds
    buffer_load_dwordx4 v2, s[40:43], s10 offen offset:1024 nt lds
    buffer_load_dwordx4 v3, s[40:43], s10 offen offset:2048 nt lds
    s_waitcnt vmcnt(2)
    buffer_load_dwordx4 v4, s[40:43], s10 offen offset:3072 nt lds
    s_xor_b32 s10, s10, 0x8000
    s_mov_b32 s44, s20
    s_and_b32 s45, s21, 0xffff
    s_mov_b32 s46, 0x4000000
    s_mov_b32 s47, 0x20000
    v_mov_b32 v12, -1
    v_mov_b32 v13, -1
    v_mov_b32 v14, -1
    v_mov_b32 v15, -1
    s_add_u32 s61, s6, 0
    s_and_b32 s61, s61, 7
    s_bfe_u32 s13, s7, 0x10003
    s_lshl_b32 s4, s61, 1
    s_add_u32 s13, s13, s4
    s_and_b32 s14, s7, 7
    s_mul_i32 s15, s6, 14
    s_add_u32 s15, s15, s7
    s_lshl_b32 s4, s6, 5
    s_add_u32 s4, s4, s7
    s_mul_i32 s4, s4, 2048
    s_add_u32 s4, s4, 131072
    s_and_b32 s9, s7, 15
    s_mul_i32 s8, s6, 14
    s_add_u32 s8, s8, s9
    s_lshr_b32 s48, s8, 2
    s_lshl_b32 s48, s48, 14
    s_and_b32 s5, s8, 3
    s_lshl_b32 s5, s5, 11
    s_add_u32 s5, s5, s48
    s_lshr_b32 s8, s7, 4
    s_lshl_b32 s8, s8, 13
    s_add_u32 s5, s5, s8
    s_add_u32 s5, s5, 786176
    v_mov_b32 v16, s4
    v_mov_b32 v17, s5
    v_cmp_gt_u32 vcc, 16, v0
    s_lshl_b32 s4, s3, 8
    s_nop 0
    v_cndmask_b32 v16, v17, v16, vcc
    v_add3_u32 v16, v16, v9, s4
    s_lshr_b32 s48, s13, 2
    s_lshl_b32 s48, s48, 14
    s_and_b32 s4, s13, 3
    s_lshl_b32 s4, s4, 11
    s_add_u32 s4, s4, s48
    s_lshl_b32 s5, s14, 8
    s_add_u32 s4, s4, s5
    s_add_u32 s4, s4, 720384
    v_bfe_u32 v17, v0, 4, 1
    v_mul_u32_u24 v17, 7936, v17
    v_add3_u32 v17, v17, v9, s4
    v_cmp_gt_u32 vcc, 32, v0
    s_cmp_lt_u32 s9, 14
    s_cselect_b32 s8, -1, 0xffff
    v_cndmask_b32 v16, v17, v16, vcc
    s_lshr_b32 s9, s7, 4
    s_cmp_lt_u32 s3, s9
    s_cselect_b32 s9, -1, 0
    s_mov_b32 exec_lo, s8
    s_mov_b32 exec_hi, s9
    global_store_dwordx4 v16, v[12:15], s[38:39] sc1
L_noc2:
    s_mov_b64 exec, -1
    v_lshrrev_b32 v10, 3, v0
    v_and_b32 v11, 7, v0
    v_lshlrev_b32 v10, 13, v10
    v_lshl_add_u32 v10, v11, 4, v10
    s_and_b32 s4, s7, 3
    s_lshl_b32 s4, s4, 3
    s_add_u32 s4, s4, s3
    s_lshl_b32 s4, s4, 7
    s_add_u32 s4, s4, s60
    s_lshl_b32 s4, s4, 3
    s_lshr_b32 s5, s7, 2
    s_add_u32 s4, s4, s5
    s_lshl_b32 s4, s4, 7
    v_add_u32 v10, s4, v10
    v_add_u32 v11, 0x10000, v10
    s_lshl_b32 s57, s3, 11
    s_add_u32 m0, s57, 8704
    s_cmp_eq_u32 s3, 0
    s_cbranch_scc0 L_nox
    s_mov_b32 m0, 1024
    s_nop 0
    global_load_lds_dwordx4 v9, s[16:17]
    s_mov_b32 m0, 8704
    s_nop 0
L_nox:
    global_load_lds_dwordx4 v10, s[22:23] nt
    s_add_u32 m0, m0, 1024
    s_nop 0
    global_load_lds_dwordx4 v11, s[22:23] nt
    s_barrier
    v_and_b32 v24, 3, v0
    v_mov_b32 v25, 0x0c0c0c0c
    v_mov_b32 v26, 0xc0c0100
    v_mov_b32 v27, 0x1000c0c
    v_cmp_eq_u32 vcc, 0, v24
    s_nop 1
    v_cndmask_b32 v16, v25, v26, vcc
    v_cmp_eq_u32 vcc, 1, v24
    s_nop 1
    v_cndmask_b32 v16, v16, v27, vcc
    v_mov_b32 v26, 0xc0c0100
    v_mov_b32 v27, 0x1000c0c
    v_cmp_eq_u32 vcc, 2, v24
    s_nop 1
    v_cndmask_b32 v17, v25, v26, vcc
    v_cmp_eq_u32 vcc, 3, v24
    s_nop 1
    v_cndmask_b32 v17, v17, v27, vcc
    v_mov_b32 v26, 0xc0c0302
    v_mov_b32 v27, 0x3020c0c
    v_cmp_eq_u32 vcc, 0, v24
    s_nop 1
    v_cndmask_b32 v18, v25, v26, vcc
    v_cmp_eq_u32 vcc, 1, v24
    s_nop 1
    v_cndmask_b32 v18, v18, v27, vcc
    v_mov_b32 v26, 0xc0c0302
    v_mov_b32 v27, 0x3020c0c
    v_cmp_eq_u32 vcc, 2, v24
    s_nop 1
    v_cndmask_b32 v19, v25, v26, vcc
    v_cmp_eq_u32 vcc, 3, v24
    s_nop 1
    v_cndmask_b32 v19, v19, v27, vcc
    v_mov_b32 v28, 0
    v_mov_b32 v29, 0
    v_mov_b32 v32, 0
    v_mov_b32 v33, 0
    v_mov_b32 v36, 0
    v_mov_b32 v37, 0
    s_mov_b32 s12, 0x3fb8aa3b
    s_getreg_b32 s48, hwreg(HW_REG_XCC_ID, 0, 4)
    v_bfe_u32 v25, v0, 2, 2
    v_lshrrev_b32 v26, 4, v0
    v_lshlrev_b32 v27, 8, v25
    v_lshl_add_u32 v38, v26, 4, v27
    v_lshl_add_u32 v25, v24, 2, v25
    v_and_b32 v27, 15, v0
    v_xor_b32 v26, v26, v27
    v_lshlrev_b32 v26, 4, v26
    v_lshl_add_u32 v26, v25, 8, v26
    v_xor_b32 v5, 0, v26
    v_add_u32 v5, s56, v5
    v_xor_b32 v6, 64, v26
    v_add_u32 v6, s56, v6
    v_xor_b32 v7, 128, v26
    v_add_u32 v7, s56, v7
    v_xor_b32 v8, 192, v26
    v_add_u32 v8, s56, v8
    s_add_u32 s61, s6, 0
    s_and_b32 s61, s61, 7
    s_bfe_u32 s13, s7, 0x10003
    s_lshl_b32 s4, s61, 1
    s_add_u32 s13, s13, s4
    s_and_b32 s14, s7, 7
    s_mul_i32 s15, s6, 14
    s_add_u32 s15, s15, s7
    s_lshl_b32 s58, s3, 12
    s_min_u32 s4, s15, 111
    s_lshl_b32 s4, s4, 3
    s_add_u32 s4, s4, s3
    s_lshl_b32 s4, s4, 11
    v_add_u32 v162, s4, v9
    s_lshl_b32 s4, s13, 3
    s_add_u32 s4, s4, s3
    s_lshl_b32 s4, s4, 15
    s_lshl_b32 s5, s14, 7
    s_add_u32 s4, s4, s5
    v_lshrrev_b32 v160, 3, v0
    v_and_b32 v161, 7, v0
    v_lshlrev_b32 v160, 10, v160
    v_lshl_add_u32 v160, v161, 4, v160
    v_add_u32 v160, s4, v160
    s_lshl_b32 s4, s61, 5
    s_add_u32 s4, s4, s7
    s_lshl_b32 s4, s4, 3
    s_add_u32 s4, s4, s3
    s_lshl_b32 s4, s4, 11
    v_add_u32 v161, s4, v9
    s_waitcnt vmcnt(2)
    buffer_load_dwordx4 v[80:83], v9, s[44:47], s11 offen offset:0 nt
    s_waitcnt vmcnt(2)
    buffer_load_dwordx4 v[84:87], v9, s[44:47], s11 offen offset:1024 nt
    s_waitcnt vmcnt(2)
    buffer_load_dwordx4 v[88:91], v9, s[44:47], s11 offen offset:2048 nt
    v_mov_b32 v24, 2304
    v_mov_b32 v25, 1
    s_mov_b64 exec, 1
    ds_add_u32 v24, v25 offset:12
    s_mov_b64 exec, -1
    s_waitcnt vmcnt(2)
    buffer_load_dwordx4 v[92:95], v9, s[44:47], s11 offen offset:3072 nt
    s_xor_b32 s11, s11, 0x8000
    s_waitcnt vmcnt(2)
    buffer_load_dwordx4 v[96:99], v9, s[44:47], s11 offen offset:0 nt
    s_waitcnt vmcnt(2)
    buffer_load_dwordx4 v[100:103], v9, s[44:47], s11 offen offset:1024 nt
    s_waitcnt vmcnt(2)
    buffer_load_dwordx4 v[104:107], v9, s[44:47], s11 offen offset:2048 nt
    s_waitcnt vmcnt(2)
    buffer_load_dwordx4 v[108:111], v9, s[44:47], s11 offen offset:3072 nt
    s_xor_b32 s11, s11, 0x18000
    s_waitcnt vmcnt(2)
    buffer_load_dwordx4 v[112:115], v9, s[44:47], s11 offen offset:0 nt
    s_waitcnt vmcnt(2)
    buffer_load_dwordx4 v[116:119], v9, s[44:47], s11 offen offset:1024 nt
    s_waitcnt vmcnt(2)
    buffer_load_dwordx4 v[120:123], v9, s[44:47], s11 offen offset:2048 nt
    s_waitcnt vmcnt(2)
    buffer_load_dwordx4 v[124:127], v9, s[44:47], s11 offen offset:3072 nt
    s_xor_b32 s11, s11, 0x8000
    s_waitcnt vmcnt(2)
    buffer_load_dwordx4 v[128:131], v9, s[44:47], s11 offen offset:0 nt
    s_waitcnt vmcnt(2)
    buffer_load_dwordx4 v[132:135], v9, s[44:47], s11 offen offset:1024 nt
    s_waitcnt vmcnt(2)
    buffer_load_dwordx4 v[136:139], v9, s[44:47], s11 offen offset:2048 nt
    v_mov_b32 v39, 2304
    ds_write_b32 v39, v39 offset:8
    s_waitcnt vmcnt(2)
    buffer_load_dwordx4 v[140:143], v9, s[44:47], s11 offen offset:3072 nt
    s_xor_b32 s11, s11, 0x38000
    s_waitcnt vmcnt(2)
    buffer_load_dwordx4 v[144:147], v9, s[44:47], s11 offen offset:0 nt
    s_waitcnt vmcnt(2)
    buffer_load_dwordx4 v[148:151], v9, s[44:47], s11 offen offset:1024 nt
    s_waitcnt vmcnt(2)
    buffer_load_dwordx4 v[152:155], v9, s[44:47], s11 offen offset:2048 nt
    s_waitcnt vmcnt(2)
    buffer_load_dwordx4 v[156:159], v9, s[44:47], s11 offen offset:3072 nt
    s_xor_b32 s11, s11, 0x8000
    s_waitcnt vmcnt(2)
    s_add_u32 m0, s56, 4096
    s_nop 0
    buffer_load_dwordx4 v1, s[40:43], s10 offen offset:0 nt lds
    s_waitcnt vmcnt(2)
    buffer_load_dwordx4 v2, s[40:43], s10 offen offset:1024 nt lds
    s_waitcnt vmcnt(2)
    buffer_load_dwordx4 v3, s[40:43], s10 offen offset:2048 nt lds
    s_waitcnt vmcnt(2)
    buffer_load_dwordx4 v4, s[40:43], s10 offen offset:3072 nt lds
    s_xor_b32 s10, s10, 0x18000
    s_waitcnt vmcnt(2)
    s_add_u32 m0, s56, 8192
    s_nop 0
    buffer_load_dwordx4 v1, s[40:43], s10 offen offset:0 nt lds
    s_waitcnt vmcnt(2)
    buffer_load_dwordx4 v2, s[40:43], s10 offen offset:1024 nt lds
    s_waitcnt vmcnt(2)
    buffer_load_dwordx4 v3, s[40:43], s10 offen offset:2048 nt lds
    s_waitcnt vmcnt(2)
    buffer_load_dwordx4 v4, s[40:43], s10 offen offset:3072 nt lds
    s_xor_b32 s10, s10, 0x8000
    v_mov_b32 v24, 2304
    s_mov_b32 s5, 0
L_waitq:
    ds_read_b32 v25, v24 offset:0
    s_waitcnt lgkmcnt(0)
    v_cmp_ne_u32 vcc, 0, v25
    s_cbranch_vccnz L_waitq_ok
    s_add_u32 s5, s5, 1
    s_cmp_lt_u32 s5, 12800000
    s_cbranch_scc0 L_waitq_ok
    s_sleep 1
    s_branch L_waitq
L_waitq_ok:
    ds_read_b128 v[48:51], v38 offset:0
    ds_read_b128 v[52:55], v38 offset:64
    ds_read_b128 v[56:59], v38 offset:128
    ds_read_b128 v[60:63], v38 offset:192
    s_waitcnt lgkmcnt(0)
    ds_read_b128 v[64:67], v5 offset:0
    ds_read_b128 v[68:71], v6 offset:0
    ds_read_b128 v[72:75], v7 offset:0
    ds_read_b128 v[76:79], v8 offset:0
    s_waitcnt lgkmcnt(3)
    v_mfma_f32_16x16x32_bf16 v[20:23], v[64:67], v[48:51], 0
    s_waitcnt lgkmcnt(2)
    v_mfma_f32_16x16x32_bf16 v[20:23], v[68:71], v[52:55], v[20:23]
    s_waitcnt lgkmcnt(1)
    v_mfma_f32_16x16x32_bf16 v[20:23], v[72:75], v[56:59], v[20:23]
    s_waitcnt lgkmcnt(0)
    v_mfma_f32_16x16x32_bf16 v[20:23], v[76:79], v[60:63], v[20:23]
    s_nop 7
    v_cvt_pk_bf16_f32 v24, v20, v21
    v_cvt_pk_bf16_f32 v25, v22, v23
    v_lshlrev_b32 v20, 16, v24
    v_and_b32 v21, 0xffff0000, v24
    v_lshlrev_b32 v22, 16, v25
    v_and_b32 v23, 0xffff0000, v25
    v_mul_f32 v20, 0x3db504f3, v20
    v_mul_f32 v21, 0x3db504f3, v21
    v_mul_f32 v22, 0x3db504f3, v22
    v_mul_f32 v23, 0x3db504f3, v23
    v_cvt_pk_bf16_f32 v24, v20, v21
    v_cvt_pk_bf16_f32 v25, v22, v23
    v_lshlrev_b32 v20, 16, v24
    v_and_b32 v21, 0xffff0000, v24
    v_lshlrev_b32 v22, 16, v25
    v_and_b32 v23, 0xffff0000, v25
    v_max_f32 v10, v20, v21
    v_max3_f32 v10, v10, v22, v23
    v_mov_b32 v24, v10
    s_nop 1
    v_permlane16_swap_b32 v10, v24
    v_max_f32 v10, v10, v24
    v_mov_b32 v24, v10
    s_nop 1
    v_permlane32_swap_b32 v10, v24
    v_max_f32 v10, v10, v24
    v_mul_f32 v11, s12, v10
    v_fma_f32 v20, v20, s12, -v11
    v_fma_f32 v21, v21, s12, -v11
    v_fma_f32 v22, v22, s12, -v11
    v_fma_f32 v23, v23, s12, -v11
    v_exp_f32 v20, v20
    v_exp_f32 v21, v21
    v_exp_f32 v22, v22
    v_exp_f32 v23, v23
    v_add_f32 v24, v20, v21
    v_add_f32 v25, v22, v23
    v_cvt_pk_bf16_f32 v13, v20, v21
    v_cvt_pk_bf16_f32 v14, v22, v23
    v_add_f32 v12, v24, v25
    s_waitcnt vmcnt(2)
    s_add_u32 m0, s56, 0
    s_nop 0
    buffer_load_dwordx4 v1, s[40:43], s10 offen offset:0 nt lds
    v_perm_b32 v30, v13, v13, v16
    v_perm_b32 v31, v13, v13, v17
    v_perm_b32 v34, v13, v13, v18
    v_perm_b32 v35, v13, v13, v19
    v_mfma_f32_16x16x32_bf16 v[40:43], v[80:83], v[30:33], 0
    v_mfma_f32_16x16x32_bf16 v[44:47], v[80:83], v[28:31], 0
    v_perm_b32 v30, v14, v14, v16
    v_perm_b32 v31, v14, v14, v17
    v_mfma_f32_16x16x32_bf16 v[40:43], v[84:87], v[34:37], v[40:43]
    v_mfma_f32_16x16x32_bf16 v[44:47], v[84:87], v[32:35], v[44:47]
    v_perm_b32 v34, v14, v14, v18
    v_perm_b32 v35, v14, v14, v19
    v_mfma_f32_16x16x32_bf16 v[40:43], v[88:91], v[30:33], v[40:43]
    v_mfma_f32_16x16x32_bf16 v[44:47], v[88:91], v[28:31], v[44:47]
    v_mfma_f32_16x16x32_bf16 v[40:43], v[92:95], v[34:37], v[40:43]
    v_mfma_f32_16x16x32_bf16 v[44:47], v[92:95], v[32:35], v[44:47]
    s_waitcnt vmcnt(2)
    buffer_load_dwordx4 v2, s[40:43], s10 offen offset:1024 nt lds
    ds_read_b128 v[64:67], v5 offset:4096
    ds_read_b128 v[68:71], v6 offset:4096
    ds_read_b128 v[72:75], v7 offset:4096
    ds_read_b128 v[76:79], v8 offset:4096
    s_waitcnt lgkmcnt(3)
    v_mfma_f32_16x16x32_bf16 v[20:23], v[64:67], v[48:51], 0
    s_waitcnt lgkmcnt(2)
    v_mfma_f32_16x16x32_bf16 v[20:23], v[68:71], v[52:55], v[20:23]
    s_waitcnt lgkmcnt(1)
    v_mfma_f32_16x16x32_bf16 v[20:23], v[72:75], v[56:59], v[20:23]
    s_waitcnt lgkmcnt(0)
    v_mfma_f32_16x16x32_bf16 v[20:23], v[76:79], v[60:63], v[20:23]
    s_nop 7
    v_cvt_pk_bf16_f32 v24, v20, v21
    v_cvt_pk_bf16_f32 v25, v22, v23
    v_lshlrev_b32 v20, 16, v24
    v_and_b32 v21, 0xffff0000, v24
    v_lshlrev_b32 v22, 16, v25
    v_and_b32 v23, 0xffff0000, v25
    v_mul_f32 v20, 0x3db504f3, v20
    v_mul_f32 v21, 0x3db504f3, v21
    v_mul_f32 v22, 0x3db504f3, v22
    v_mul_f32 v23, 0x3db504f3, v23
    v_cvt_pk_bf16_f32 v24, v20, v21
    v_cvt_pk_bf16_f32 v25, v22, v23
    v_lshlrev_b32 v20, 16, v24
    v_and_b32 v21, 0xffff0000, v24
    v_lshlrev_b32 v22, 16, v25
    v_and_b32 v23, 0xffff0000, v25
    v_max3_f32 v10, v10, v20, v21
    v_max3_f32 v10, v10, v22, v23
    v_mov_b32 v24, v10
    s_nop 1
    v_permlane16_swap_b32 v10, v24
    v_max_f32 v10, v10, v24
    v_mov_b32 v24, v10
    s_nop 1
    v_permlane32_swap_b32 v10, v24
    v_max_f32 v10, v10, v24
    v_mov_b32 v15, v11
    v_mul_f32 v11, s12, v10
    v_sub_f32 v15, v15, v11
    v_exp_f32 v15, v15
    v_fma_f32 v20, v20, s12, -v11
    v_fma_f32 v21, v21, s12, -v11
    v_fma_f32 v22, v22, s12, -v11
    v_fma_f32 v23, v23, s12, -v11
    v_exp_f32 v20, v20
    v_exp_f32 v21, v21
    v_exp_f32 v22, v22
    v_exp_f32 v23, v23
    v_mul_f32 v40, v15, v40
    v_mul_f32 v41, v15, v41
    v_mul_f32 v42, v15, v42
    v_mul_f32 v43, v15, v43
    v_mul_f32 v44, v15, v44
    v_mul_f32 v45, v15, v45
    v_mul_f32 v46, v15, v46
    v_mul_f32 v47, v15, v47
    v_mul_f32 v12, v12, v15
    v_add_f32 v24, v20, v21
    v_add_f32 v25, v22, v23
    v_cvt_pk_bf16_f32 v13, v20, v21
    v_cvt_pk_bf16_f32 v14, v22, v23
    v_add_f32 v24, v24, v25
    v_add_f32 v12, v12, v24
    s_waitcnt vmcnt(2)
    buffer_load_dwordx4 v3, s[40:43], s10 offen offset:2048 nt lds
    v_perm_b32 v30, v13, v13, v16
    v_perm_b32 v31, v13, v13, v17
    v_perm_b32 v34, v13, v13, v18
    v_perm_b32 v35, v13, v13, v19
    v_mfma_f32_16x16x32_bf16 v[40:43], v[96:99], v[30:33], v[40:43]
    v_mfma_f32_16x16x32_bf16 v[44:47], v[96:99], v[28:31], v[44:47]
    v_perm_b32 v30, v14, v14, v16
    v_perm_b32 v31, v14, v14, v17
    v_mfma_f32_16x16x32_bf16 v[40:43], v[100:103], v[34:37], v[40:43]
    v_mfma_f32_16x16x32_bf16 v[44:47], v[100:103], v[32:35], v[44:47]
    v_perm_b32 v34, v14, v14, v18
    v_perm_b32 v35, v14, v14, v19
    v_mfma_f32_16x16x32_bf16 v[40:43], v[104:107], v[30:33], v[40:43]
    v_mfma_f32_16x16x32_bf16 v[44:47], v[104:107], v[28:31], v[44:47]
    v_mfma_f32_16x16x32_bf16 v[40:43], v[108:111], v[34:37], v[40:43]
    v_mfma_f32_16x16x32_bf16 v[44:47], v[108:111], v[32:35], v[44:47]
    s_waitcnt vmcnt(2)
    buffer_load_dwordx4 v4, s[40:43], s10 offen offset:3072 nt lds
    s_xor_b32 s10, s10, 0x38000
    ds_read_b128 v[64:67], v5 offset:8192
    ds_read_b128 v[68:71], v6 offset:8192
    ds_read_b128 v[72:75], v7 offset:8192
    ds_read_b128 v[76:79], v8 offset:8192
    s_waitcnt lgkmcnt(3)
    v_mfma_f32_16x16x32_bf16 v[20:23], v[64:67], v[48:51], 0
    s_waitcnt lgkmcnt(2)
    v_mfma_f32_16x16x32_bf16 v[20:23], v[68:71], v[52:55], v[20:23]
    s_waitcnt lgkmcnt(1)
    v_mfma_f32_16x16x32_bf16 v[20:23], v[72:75], v[56:59], v[20:23]
    s_waitcnt lgkmcnt(0)
    v_mfma_f32_16x16x32_bf16 v[20:23], v[76:79], v[60:63], v[20:23]
    s_nop 7
    v_cvt_pk_bf16_f32 v24, v20, v21
    v_cvt_pk_bf16_f32 v25, v22, v23
    v_lshlrev_b32 v20, 16, v24
    v_and_b32 v21, 0xffff0000, v24
    v_lshlrev_b32 v22, 16, v25
    v_and_b32 v23, 0xffff0000, v25
    v_mul_f32 v20, 0x3db504f3, v20
    v_mul_f32 v21, 0x3db504f3, v21
    v_mul_f32 v22, 0x3db504f3, v22
    v_mul_f32 v23, 0x3db504f3, v23
    v_cvt_pk_bf16_f32 v24, v20, v21
    v_cvt_pk_bf16_f32 v25, v22, v23
    v_lshlrev_b32 v20, 16, v24
    v_and_b32 v21, 0xffff0000, v24
    v_lshlrev_b32 v22, 16, v25
    v_and_b32 v23, 0xffff0000, v25
    v_max3_f32 v10, v10, v20, v21
    v_max3_f32 v10, v10, v22, v23
    v_mov_b32 v24, v10
    s_nop 1
    v_permlane16_swap_b32 v10, v24
    v_max_f32 v10, v10, v24
    v_mov_b32 v24, v10
    s_nop 1
    v_permlane32_swap_b32 v10, v24
    v_max_f32 v10, v10, v24
    v_mov_b32 v15, v11
    v_mul_f32 v11, s12, v10
    v_sub_f32 v15, v15, v11
    v_exp_f32 v15, v15
    v_fma_f32 v20, v20, s12, -v11
    v_fma_f32 v21, v21, s12, -v11
    v_fma_f32 v22, v22, s12, -v11
    v_fma_f32 v23, v23, s12, -v11
    v_exp_f32 v20, v20
    v_exp_f32 v21, v21
    v_exp_f32 v22, v22
    v_exp_f32 v23, v23
    v_mul_f32 v40, v15, v40
    v_mul_f32 v41, v15, v41
    v_mul_f32 v42, v15, v42
    v_mul_f32 v43, v15, v43
    v_mul_f32 v44, v15, v44
    v_mul_f32 v45, v15, v45
    v_mul_f32 v46, v15, v46
    v_mul_f32 v47, v15, v47
    v_mul_f32 v12, v12, v15
    v_add_f32 v24, v20, v21
    v_add_f32 v25, v22, v23
    v_cvt_pk_bf16_f32 v13, v20, v21
    v_cvt_pk_bf16_f32 v14, v22, v23
    v_add_f32 v24, v24, v25
    v_add_f32 v12, v12, v24
    s_waitcnt vmcnt(2)
    s_add_u32 m0, s56, 4096
    s_nop 0
    buffer_load_dwordx4 v1, s[40:43], s10 offen offset:0 nt lds
    v_perm_b32 v30, v13, v13, v16
    v_perm_b32 v31, v13, v13, v17
    v_perm_b32 v34, v13, v13, v18
    v_perm_b32 v35, v13, v13, v19
    v_mfma_f32_16x16x32_bf16 v[40:43], v[112:115], v[30:33], v[40:43]
    v_mfma_f32_16x16x32_bf16 v[44:47], v[112:115], v[28:31], v[44:47]
    v_perm_b32 v30, v14, v14, v16
    v_perm_b32 v31, v14, v14, v17
    v_mfma_f32_16x16x32_bf16 v[40:43], v[116:119], v[34:37], v[40:43]
    v_mfma_f32_16x16x32_bf16 v[44:47], v[116:119], v[32:35], v[44:47]
    v_perm_b32 v34, v14, v14, v18
    v_perm_b32 v35, v14, v14, v19
    v_mfma_f32_16x16x32_bf16 v[40:43], v[120:123], v[30:33], v[40:43]
    v_mfma_f32_16x16x32_bf16 v[44:47], v[120:123], v[28:31], v[44:47]
    v_mfma_f32_16x16x32_bf16 v[40:43], v[124:127], v[34:37], v[40:43]
    v_mfma_f32_16x16x32_bf16 v[44:47], v[124:127], v[32:35], v[44:47]
    s_waitcnt vmcnt(2)
    buffer_load_dwordx4 v2, s[40:43], s10 offen offset:1024 nt lds
    s_waitcnt vmcnt(2)
    buffer_load_dwordx4 v3, s[40:43], s10 offen offset:2048 nt lds
    ds_read_b128 v[64:67], v5 offset:0
    ds_read_b128 v[68:71], v6 offset:0
    ds_read_b128 v[72:75], v7 offset:0
    ds_read_b128 v[76:79], v8 offset:0
    s_waitcnt lgkmcnt(3)
    v_mfma_f32_16x16x32_bf16 v[20:23], v[64:67], v[48:51], 0
    s_waitcnt lgkmcnt(2)
    v_mfma_f32_16x16x32_bf16 v[20:23], v[68:71], v[52:55], v[20:23]
    s_waitcnt lgkmcnt(1)
    v_mfma_f32_16x16x32_bf16 v[20:23], v[72:75], v[56:59], v[20:23]
    s_waitcnt lgkmcnt(0)
    v_mfma_f32_16x16x32_bf16 v[20:23], v[76:79], v[60:63], v[20:23]
    s_nop 7
    v_cvt_pk_bf16_f32 v24, v20, v21
    v_cvt_pk_bf16_f32 v25, v22, v23
    v_lshlrev_b32 v20, 16, v24
    v_and_b32 v21, 0xffff0000, v24
    v_lshlrev_b32 v22, 16, v25
    v_and_b32 v23, 0xffff0000, v25
    v_mul_f32 v20, 0x3db504f3, v20
    v_mul_f32 v21, 0x3db504f3, v21
    v_mul_f32 v22, 0x3db504f3, v22
    v_mul_f32 v23, 0x3db504f3, v23
    v_cvt_pk_bf16_f32 v24, v20, v21
    v_cvt_pk_bf16_f32 v25, v22, v23
    v_lshlrev_b32 v20, 16, v24
    v_and_b32 v21, 0xffff0000, v24
    v_lshlrev_b32 v22, 16, v25
    v_and_b32 v23, 0xffff0000, v25
    v_max3_f32 v10, v10, v20, v21
    v_max3_f32 v10, v10, v22, v23
    v_mov_b32 v24, v10
    s_nop 1
    v_permlane16_swap_b32 v10, v24
    v_max_f32 v10, v10, v24
    v_mov_b32 v24, v10
    s_nop 1
    v_permlane32_swap_b32 v10, v24
    v_max_f32 v10, v10, v24
    v_mov_b32 v15, v11
    v_mul_f32 v11, s12, v10
    v_sub_f32 v15, v15, v11
    v_exp_f32 v15, v15
    v_fma_f32 v20, v20, s12, -v11
    v_fma_f32 v21, v21, s12, -v11
    v_fma_f32 v22, v22, s12, -v11
    v_fma_f32 v23, v23, s12, -v11
    v_exp_f32 v20, v20
    v_exp_f32 v21, v21
    v_exp_f32 v22, v22
    v_exp_f32 v23, v23
    v_mul_f32 v40, v15, v40
    v_mul_f32 v41, v15, v41
    v_mul_f32 v42, v15, v42
    v_mul_f32 v43, v15, v43
    v_mul_f32 v44, v15, v44
    v_mul_f32 v45, v15, v45
    v_mul_f32 v46, v15, v46
    v_mul_f32 v47, v15, v47
    v_mul_f32 v12, v12, v15
    v_add_f32 v24, v20, v21
    v_add_f32 v25, v22, v23
    v_cvt_pk_bf16_f32 v13, v20, v21
    v_cvt_pk_bf16_f32 v14, v22, v23
    v_add_f32 v24, v24, v25
    v_add_f32 v12, v12, v24
    s_waitcnt vmcnt(2)
    buffer_load_dwordx4 v4, s[40:43], s10 offen offset:3072 nt lds
    s_xor_b32 s10, s10, 0x8000
    v_perm_b32 v30, v13, v13, v16
    v_perm_b32 v31, v13, v13, v17
    v_perm_b32 v34, v13, v13, v18
    v_perm_b32 v35, v13, v13, v19
    v_mfma_f32_16x16x32_bf16 v[40:43], v[128:131], v[30:33], v[40:43]
    v_mfma_f32_16x16x32_bf16 v[44:47], v[128:131], v[28:31], v[44:47]
    v_perm_b32 v30, v14, v14, v16
    v_perm_b32 v31, v14, v14, v17
    v_mfma_f32_16x16x32_bf16 v[40:43], v[132:135], v[34:37], v[40:43]
    v_mfma_f32_16x16x32_bf16 v[44:47], v[132:135], v[32:35], v[44:47]
    v_perm_b32 v34, v14, v14, v18
    v_perm_b32 v35, v14, v14, v19
    v_mfma_f32_16x16x32_bf16 v[40:43], v[136:139], v[30:33], v[40:43]
    v_mfma_f32_16x16x32_bf16 v[44:47], v[136:139], v[28:31], v[44:47]
    v_mfma_f32_16x16x32_bf16 v[40:43], v[140:143], v[34:37], v[40:43]
    v_mfma_f32_16x16x32_bf16 v[44:47], v[140:143], v[32:35], v[44:47]
    s_waitcnt vmcnt(2)
    s_add_u32 m0, s56, 8192
    s_nop 0
    buffer_load_dwordx4 v1, s[40:43], s10 offen offset:0 nt lds
    s_waitcnt vmcnt(2)
    buffer_load_dwordx4 v2, s[40:43], s10 offen offset:1024 nt lds
    s_waitcnt vmcnt(2)
    buffer_load_dwordx4 v3, s[40:43], s10 offen offset:2048 nt lds
    ds_read_b128 v[64:67], v5 offset:4096
    ds_read_b128 v[68:71], v6 offset:4096
    ds_read_b128 v[72:75], v7 offset:4096
    ds_read_b128 v[76:79], v8 offset:4096
    s_waitcnt lgkmcnt(3)
    v_mfma_f32_16x16x32_bf16 v[20:23], v[64:67], v[48:51], 0
    s_waitcnt lgkmcnt(2)
    v_mfma_f32_16x16x32_bf16 v[20:23], v[68:71], v[52:55], v[20:23]
    s_waitcnt lgkmcnt(1)
    v_mfma_f32_16x16x32_bf16 v[20:23], v[72:75], v[56:59], v[20:23]
    s_waitcnt lgkmcnt(0)
    v_mfma_f32_16x16x32_bf16 v[20:23], v[76:79], v[60:63], v[20:23]
    s_nop 7
    v_cvt_pk_bf16_f32 v24, v20, v21
    v_cvt_pk_bf16_f32 v25, v22, v23
    v_lshlrev_b32 v20, 16, v24
    v_and_b32 v21, 0xffff0000, v24
    v_lshlrev_b32 v22, 16, v25
    v_and_b32 v23, 0xffff0000, v25
    v_mul_f32 v20, 0x3db504f3, v20
    v_mul_f32 v21, 0x3db504f3, v21
    v_mul_f32 v22, 0x3db504f3, v22
    v_mul_f32 v23, 0x3db504f3, v23
    v_cvt_pk_bf16_f32 v24, v20, v21
    v_cvt_pk_bf16_f32 v25, v22, v23
    v_lshlrev_b32 v20, 16, v24
    v_and_b32 v21, 0xffff0000, v24
    v_lshlrev_b32 v22, 16, v25
    v_and_b32 v23, 0xffff0000, v25
    v_max3_f32 v10, v10, v20, v21
    v_max3_f32 v10, v10, v22, v23
    v_mov_b32 v24, v10
    s_nop 1
    v_permlane16_swap_b32 v10, v24
    v_max_f32 v10, v10, v24
    v_mov_b32 v24, v10
    s_nop 1
    v_permlane32_swap_b32 v10, v24
    v_max_f32 v10, v10, v24
    v_mov_b32 v15, v11
    v_mul_f32 v11, s12, v10
    v_sub_f32 v15, v15, v11
    v_exp_f32 v15, v15
    v_fma_f32 v20, v20, s12, -v11
    v_fma_f32 v21, v21, s12, -v11
    v_fma_f32 v22, v22, s12, -v11
    v_fma_f32 v23, v23, s12, -v11
    v_exp_f32 v20, v20
    v_exp_f32 v21, v21
    v_exp_f32 v22, v22
    v_exp_f32 v23, v23
    v_mul_f32 v40, v15, v40
    v_mul_f32 v41, v15, v41
    v_mul_f32 v42, v15, v42
    v_mul_f32 v43, v15, v43
    v_mul_f32 v44, v15, v44
    v_mul_f32 v45, v15, v45
    v_mul_f32 v46, v15, v46
    v_mul_f32 v47, v15, v47
    v_mul_f32 v12, v12, v15
    v_add_f32 v24, v20, v21
    v_add_f32 v25, v22, v23
    v_cvt_pk_bf16_f32 v13, v20, v21
    v_cvt_pk_bf16_f32 v14, v22, v23
    v_add_f32 v24, v24, v25
    v_add_f32 v12, v12, v24
    s_waitcnt vmcnt(2)
    buffer_load_dwordx4 v4, s[40:43], s10 offen offset:3072 nt lds
    s_xor_b32 s10, s10, 0x18000
    v_perm_b32 v30, v13, v13, v16
    v_perm_b32 v31, v13, v13, v17
    v_perm_b32 v34, v13, v13, v18
    v_perm_b32 v35, v13, v13, v19
    v_mfma_f32_16x16x32_bf16 v[40:43], v[144:147], v[30:33], v[40:43]
    v_mfma_f32_16x16x32_bf16 v[44:47], v[144:147], v[28:31], v[44:47]
    v_perm_b32 v30, v14, v14, v16
    v_perm_b32 v31, v14, v14, v17
    v_mfma_f32_16x16x32_bf16 v[40:43], v[148:151], v[34:37], v[40:43]
    v_mfma_f32_16x16x32_bf16 v[44:47], v[148:151], v[32:35], v[44:47]
    v_perm_b32 v34, v14, v14, v18
    v_perm_b32 v35, v14, v14, v19
    v_mfma_f32_16x16x32_bf16 v[40:43], v[152:155], v[30:33], v[40:43]
    v_mfma_f32_16x16x32_bf16 v[44:47], v[152:155], v[28:31], v[44:47]
    v_mfma_f32_16x16x32_bf16 v[40:43], v[156:159], v[34:37], v[40:43]
    v_mfma_f32_16x16x32_bf16 v[44:47], v[156:159], v[32:35], v[44:47]
    s_waitcnt vmcnt(2)
    s_add_u32 m0, s56, 0
    s_nop 0
    buffer_load_dwordx4 v1, s[40:43], s10 offen offset:0 nt lds
    ds_write_b32 v39, v39 offset:20
    s_waitcnt vmcnt(2)
    buffer_load_dwordx4 v2, s[40:43], s10 offen offset:1024 nt lds
    s_waitcnt vmcnt(2)
    buffer_load_dwordx4 v3, s[40:43], s10 offen offset:2048 nt lds
    ds_read_b128 v[64:67], v5 offset:8192
    ds_read_b128 v[68:71], v6 offset:8192
    ds_read_b128 v[72:75], v7 offset:8192
    ds_read_b128 v[76:79], v8 offset:8192
    s_waitcnt lgkmcnt(3)
    v_mfma_f32_16x16x32_bf16 v[144:147], v[64:67], v[48:51], 0
    s_waitcnt lgkmcnt(2)
    v_mfma_f32_16x16x32_bf16 v[144:147], v[68:71], v[52:55], v[144:147]
    s_waitcnt lgkmcnt(1)
    v_mfma_f32_16x16x32_bf16 v[144:147], v[72:75], v[56:59], v[144:147]
    s_waitcnt lgkmcnt(0)
    v_mfma_f32_16x16x32_bf16 v[144:147], v[76:79], v[60:63], v[144:147]
    s_nop 7
    v_cvt_pk_bf16_f32 v24, v144, v145
    v_cvt_pk_bf16_f32 v25, v146, v147
    v_lshlrev_b32 v144, 16, v24
    v_and_b32 v145, 0xffff0000, v24
    v_lshlrev_b32 v146, 16, v25
    v_and_b32 v147, 0xffff0000, v25
    v_mul_f32 v144, 0x3db504f3, v144
    v_mul_f32 v145, 0x3db504f3, v145
    v_mul_f32 v146, 0x3db504f3, v146
    v_mul_f32 v147, 0x3db504f3, v147
    v_cvt_pk_bf16_f32 v24, v144, v145
    v_cvt_pk_bf16_f32 v25, v146, v147
    v_lshlrev_b32 v144, 16, v24
    v_and_b32 v145, 0xffff0000, v24
    v_lshlrev_b32 v146, 16, v25
    v_and_b32 v147, 0xffff0000, v25
    v_max3_f32 v10, v10, v144, v145
    v_max3_f32 v10, v10, v146, v147
    s_waitcnt vmcnt(2)
    buffer_load_dwordx4 v4, s[40:43], s10 offen offset:3072 nt lds
    s_xor_b32 s10, s10, 0x8000
    s_waitcnt vmcnt(2)
    s_add_u32 m0, s56, 4096
    s_nop 0
    buffer_load_dwordx4 v1, s[40:43], s10 offen offset:0 nt lds
    s_waitcnt vmcnt(2)
    buffer_load_dwordx4 v2, s[40:43], s10 offen offset:1024 nt lds
    s_bitcmp1_b32 s48, 0
    s_cbranch_scc1 L_bo50
    s_waitcnt vmcnt(2)
L_bo50:
    buffer_load_dwordx4 v3, s[40:43], s10 offen offset:2048 nt lds
    s_waitcnt vmcnt(3)
    s_bitcmp1_b32 s48, 0
    s_cbranch_scc1 L_bo51
    s_waitcnt vmcnt(2)
L_bo51:
    buffer_load_dwordx4 v4, s[40:43], s10 offen offset:3072 nt lds
    ds_read_b128 v[64:67], v5 offset:0
    ds_read_b128 v[68:71], v6 offset:0
    ds_read_b128 v[72:75], v7 offset:0
    ds_read_b128 v[76:79], v8 offset:0
    s_waitcnt lgkmcnt(3)
    v_mfma_f32_16x16x32_bf16 v[148:151], v[64:67], v[48:51], 0
    s_waitcnt lgkmcnt(2)
    v_mfma_f32_16x16x32_bf16 v[148:151], v[68:71], v[52:55], v[148:151]
    s_waitcnt lgkmcnt(1)
    v_mfma_f32_16x16x32_bf16 v[148:151], v[72:75], v[56:59], v[148:151]
    s_waitcnt lgkmcnt(0)
    v_mfma_f32_16x16x32_bf16 v[148:151], v[76:79], v[60:63], v[148:151]
    s_nop 7
    v_cvt_pk_bf16_f32 v24, v148, v149
    v_cvt_pk_bf16_f32 v25, v150, v151
    v_lshlrev_b32 v148, 16, v24
    v_and_b32 v149, 0xffff0000, v24
    v_lshlrev_b32 v150, 16, v25
    v_and_b32 v151, 0xffff0000, v25
    v_mul_f32 v148, 0x3db504f3, v148
    v_mul_f32 v149, 0x3db504f3, v149
    v_mul_f32 v150, 0x3db504f3, v150
    v_mul_f32 v151, 0x3db504f3, v151
    v_cvt_pk_bf16_f32 v24, v148, v149
    v_cvt_pk_bf16_f32 v25, v150, v151
    v_lshlrev_b32 v148, 16, v24
    v_and_b32 v149, 0xffff0000, v24
    v_lshlrev_b32 v150, 16, v25
    v_and_b32 v151, 0xffff0000, v25
    v_max3_f32 v10, v10, v148, v149
    v_max3_f32 v10, v10, v150, v151
    s_waitcnt vmcnt(3)
    s_bitcmp1_b32 s48, 0
    s_cbranch_scc1 L_bo52
    s_waitcnt vmcnt(2)
L_bo52:
    buffer_load_dwordx4 v[80:83], v9, s[44:47], s11 offen offset:0 nt
    s_waitcnt vmcnt(3)
    s_bitcmp1_b32 s48, 0
    s_cbranch_scc1 L_bo53
    s_waitcnt vmcnt(2)
L_bo53:
    buffer_load_dwordx4 v[84:87], v9, s[44:47], s11 offen offset:1024 nt
    s_waitcnt vmcnt(3)
    s_bitcmp1_b32 s48, 0
    s_cbranch_scc1 L_bo54
    s_waitcnt vmcnt(2)
L_bo54:
    buffer_load_dwordx4 v[88:91], v9, s[44:47], s11 offen offset:2048 nt
    s_waitcnt vmcnt(3)
    s_bitcmp1_b32 s48, 0
    s_cbranch_scc1 L_bo55
    s_waitcnt vmcnt(2)
L_bo55:
    buffer_load_dwordx4 v[92:95], v9, s[44:47], s11 offen offset:3072 nt
    s_xor_b32 s11, s11, 0x18000
    ds_read_b128 v[64:67], v5 offset:4096
    ds_read_b128 v[68:71], v6 offset:4096
    ds_read_b128 v[72:75], v7 offset:4096
    ds_read_b128 v[76:79], v8 offset:4096
    s_waitcnt lgkmcnt(3)
    v_mfma_f32_16x16x32_bf16 v[152:155], v[64:67], v[48:51], 0
    s_waitcnt lgkmcnt(2)
    v_mfma_f32_16x16x32_bf16 v[152:155], v[68:71], v[52:55], v[152:155]
    s_waitcnt lgkmcnt(1)
    v_mfma_f32_16x16x32_bf16 v[152:155], v[72:75], v[56:59], v[152:155]
    s_waitcnt lgkmcnt(0)
    v_mfma_f32_16x16x32_bf16 v[152:155], v[76:79], v[60:63], v[152:155]
    s_nop 7
    v_cvt_pk_bf16_f32 v24, v152, v153
    v_cvt_pk_bf16_f32 v25, v154, v155
    v_lshlrev_b32 v152, 16, v24
    v_and_b32 v153, 0xffff0000, v24
    v_lshlrev_b32 v154, 16, v25
    v_and_b32 v155, 0xffff0000, v25
    v_mul_f32 v152, 0x3db504f3, v152
    v_mul_f32 v153, 0x3db504f3, v153
    v_mul_f32 v154, 0x3db504f3, v154
    v_mul_f32 v155, 0x3db504f3, v155
    v_cvt_pk_bf16_f32 v24, v152, v153
    v_cvt_pk_bf16_f32 v25, v154, v155
    v_lshlrev_b32 v152, 16, v24
    v_and_b32 v153, 0xffff0000, v24
    v_lshlrev_b32 v154, 16, v25
    v_and_b32 v155, 0xffff0000, v25
    v_max3_f32 v10, v10, v152, v153
    v_max3_f32 v10, v10, v154, v155
    v_mov_b32 v24, v10
    s_nop 1
    v_permlane16_swap_b32 v10, v24
    v_max_f32 v10, v10, v24
    v_mov_b32 v24, v10
    s_nop 1
    v_permlane32_swap_b32 v10, v24
    v_max_f32 v10, v10, v24
    v_bfe_u32 v26, v0, 2, 2
    v_lshlrev_b32 v26, 5, v26
    s_lshl_b32 s4, s3, 2
    v_add_u32 v27, s4, v26
    s_mov_b64 exec, 0x1111
    ds_write_b32 v27, v10 offset:2048
    s_mov_b64 exec, -1
    s_waitcnt vmcnt(3)
    s_bitcmp1_b32 s48, 0
    s_cbranch_scc1 L_bo56
    s_waitcnt vmcnt(2)
L_bo56:
    buffer_load_dwordx4 v[96:99], v9, s[44:47], s11 offen offset:0 nt
    s_waitcnt lgkmcnt(0)
    s_barrier
    ds_read_b128 v[64:67], v26 offset:2048
    ds_read_b128 v[68:71], v26 offset:2064
    s_waitcnt lgkmcnt(0)
    v_max3_f32 v10, v64, v65, v66
    v_max3_f32 v10, v10, v67, v68
    v_max3_f32 v10, v10, v69, v70
    v_max_f32 v10, v10, v71
    v_mov_b32 v15, v11
    v_mul_f32 v11, s12, v10
    v_sub_f32 v15, v15, v11
    v_exp_f32 v15, v15
    v_fma_f32 v144, v144, s12, -v11
    v_fma_f32 v145, v145, s12, -v11
    v_fma_f32 v146, v146, s12, -v11
    v_fma_f32 v147, v147, s12, -v11
    v_fma_f32 v148, v148, s12, -v11
    v_fma_f32 v149, v149, s12, -v11
    v_fma_f32 v150, v150, s12, -v11
    v_fma_f32 v151, v151, s12, -v11
    v_fma_f32 v152, v152, s12, -v11
    v_fma_f32 v153, v153, s12, -v11
    v_fma_f32 v154, v154, s12, -v11
    v_fma_f32 v155, v155, s12, -v11
    v_exp_f32 v144, v144
    v_exp_f32 v145, v145
    v_exp_f32 v146, v146
    v_exp_f32 v147, v147
    v_exp_f32 v148, v148
    v_exp_f32 v149, v149
    v_exp_f32 v150, v150
    v_exp_f32 v151, v151
    v_exp_f32 v152, v152
    v_exp_f32 v153, v153
    v_exp_f32 v154, v154
    v_exp_f32 v155, v155
    v_mul_f32 v40, v15, v40
    v_mul_f32 v41, v15, v41
    v_mul_f32 v42, v15, v42
    v_mul_f32 v43, v15, v43
    v_mul_f32 v44, v15, v44
    v_mul_f32 v45, v15, v45
    v_mul_f32 v46, v15, v46
    v_mul_f32 v47, v15, v47
    v_mul_f32 v12, v12, v15
    v_add_f32 v24, v144, v145
    v_add_f32 v25, v146, v147
    v_cvt_pk_bf16_f32 v128, v144, v145
    v_cvt_pk_bf16_f32 v129, v146, v147
    v_add_f32 v24, v24, v25
    v_add_f32 v12, v12, v24
    v_add_f32 v24, v148, v149
    v_add_f32 v25, v150, v151
    v_cvt_pk_bf16_f32 v130, v148, v149
    v_cvt_pk_bf16_f32 v131, v150, v151
    v_add_f32 v24, v24, v25
    v_add_f32 v12, v12, v24
    v_add_f32 v24, v152, v153
    v_add_f32 v25, v154, v155
    v_cvt_pk_bf16_f32 v132, v152, v153
    v_cvt_pk_bf16_f32 v133, v154, v155
    v_add_f32 v24, v24, v25
    v_add_f32 v12, v12, v24
    v_mov_b32 v24, v12
    s_nop 1
    v_permlane16_swap_b32 v12, v24
    v_add_f32 v12, v12, v24
    v_mov_b32 v24, v12
    s_nop 1
    v_permlane32_swap_b32 v12, v24
    v_add_f32 v12, v12, v24
    s_mov_b64 exec, 0x1111
    ds_write_b32 v27, v12 offset:2176
    s_mov_b64 exec, -1
    s_waitcnt vmcnt(3)
    s_bitcmp1_b32 s48, 0
    s_cbranch_scc1 L_bo57
    s_waitcnt vmcnt(2)
L_bo57:
    buffer_load_dwordx4 v[100:103], v9, s[44:47], s11 offen offset:1024 nt
    s_and_b32 s4, s3, 1
    s_lshl_b32 s4, s4, 6
    v_lshrrev_b32 v26, 5, v0
    v_lshl_add_u32 v26, v26, 5, s4
    v_mov_b32 v27, 2304
    s_waitcnt lgkmcnt(0)
    s_barrier
    ds_read_b128 v[64:67], v26 offset:2048
    ds_read_b128 v[68:71], v26 offset:2064
    ds_read_b128 v[72:75], v26 offset:2176
    ds_read_b128 v[76:79], v26 offset:2192
    ds_read2_b32 v[26:27], v27 offset0:4 offset1:1
    s_waitcnt lgkmcnt(0)
    v_max3_f32 v64, v64, v65, v66
    v_max3_f32 v64, v64, v67, v68
    v_max3_f32 v64, v64, v69, v70
    v_max_f32 v64, v64, v71
    v_add_f32 v72, v72, v76
    v_add_f32 v73, v73, v77
    v_add_f32 v74, v74, v78
    v_add_f32 v75, v75, v79
    v_add_f32 v72, v72, v73
    v_add_f32 v74, v74, v75
    v_add_f32 v72, v72, v74
    v_readfirstlane_b32 s62, v27
    v_readfirstlane_b32 s49, v26
    v_log_f32 v73, v72
    v_rcp_f32 v15, v72
    v_mul_f32 v64, s12, v64
    v_add_f32 v12, v64, v73
    v_and_b32 v10, 3, v0
    v_add_u32 v10, 0x07060501, v10
    s_mov_b32 s50, 0x88888888
    s_mov_b32 s51, 0x88888888
    s_waitcnt vmcnt(3)
    s_bitcmp1_b32 s48, 0
    s_cbranch_scc1 L_bo58
    s_waitcnt vmcnt(2)
L_bo58:
    buffer_load_dwordx4 v[104:107], v9, s[44:47], s11 offen offset:2048 nt
    v_add_u32 v64, s56, v9
    v_and_b32 v65, 15, v0
    v_bfe_u32 v66, v0, 4, 1
    v_mul_u32_u24 v66, 272, v66
    v_add_u32 v65, v65, v66
    v_lshrrev_b32 v66, 5, v0
    v_lshl_add_u32 v65, v66, 4, v65
    s_lshl_b32 s4, s3, 7
    s_add_u32 s4, s4, 57856
    v_lshl_add_u32 v65, v65, 2, s4
    v_add_u32 v66, 49152, v65
    s_lshl_b32 s4, s6, 5
    s_add_u32 s4, s4, s7
    s_mul_i32 s4, s4, 2048
    s_add_u32 s4, s4, 131072
    s_lshl_b32 s5, s3, 8
    s_add_u32 s5, s5, s4
    v_lshl_add_u32 v67, v0, 2, s5
    s_waitcnt vmcnt(3)
    s_bitcmp1_b32 s48, 0
    s_cbranch_scc1 L_bo59
    s_waitcnt vmcnt(2)
L_bo59:
    buffer_load_dwordx4 v[108:111], v9, s[44:47], s11 offen offset:3072 nt
    s_xor_b32 s11, s11, 0x8000
    s_lshl_b32 s4, s61, 5
    v_lshrrev_b32 v57, 3, v0
    v_add_u32 v57, s4, v57
    v_mul_u32_u24 v57, 2048, v57
    s_and_b32 s4, s13, 1
    s_lshl_b32 s4, s4, 1
    s_lshr_b32 s5, s3, 2
    s_add_u32 s4, s4, s5
    s_and_b32 s5, s3, 3
    s_lshl_b32 s5, s5, 2
    s_add_u32 s4, s4, s5
    s_lshl_b32 s4, s4, 7
    s_add_u32 s4, s4, 131072
    v_and_b32 v58, 7, v0
    v_lshl_add_u32 v57, v58, 4, v57
    v_add_u32 v48, s4, v57
    v_add_u32 v49, 16384, v48
    v_add_u32 v50, 32768, v48
    v_add_u32 v51, 49152, v48
    s_mov_b32 s52, 0x04000c0c
    s_mov_b32 s53, 0x0706000c
    s_mov_b32 s54, 0xffff0000
    s_mov_b32 s55, 0xffff0000
    s_mov_b32 s8, 0
    s_mov_b32 s9, -1
    v_bfe_u32 v57, v0, 4, 1
    v_lshrrev_b32 v58, 5, v0
    v_lshl_add_u32 v57, v57, 1, v58
    v_bfe_u32 v58, v0, 2, 2
    v_lshl_add_u32 v57, v57, 3, v58
    v_lshlrev_b32 v57, 7, v57
    v_and_b32 v58, 3, v0
    v_lshl_add_u32 v57, v58, 3, v57
    s_lshl_b32 s4, s3, 12
    v_add_u32 v52, s4, v57
    v_lshlrev_b32 v54, 2, v0
    s_lshl_b32 s4, s3, 8
    v_add_u32 v53, s4, v54
    s_lshr_b32 s5, s13, 2
    s_lshl_b32 s5, s5, 14
    s_and_b32 s4, s13, 3
    s_lshl_b32 s4, s4, 11
    s_add_u32 s4, s4, s5
    s_lshl_b32 s5, s14, 8
    s_add_u32 s4, s4, s5
    s_add_u32 s4, s4, 720896
    s_mov_b32 s5, s49
    s_xor_b32 s5, s5, 0x2000
    s_add_u32 s4, s4, s5
    v_add_u32 v55, s4, v54
    v_xor_b32 v56, 0x2000, v55
    s_waitcnt vmcnt(3)
    s_bitcmp1_b32 s48, 0
    s_cbranch_scc1 L_bo60
    s_waitcnt vmcnt(2)
L_bo60:
    buffer_load_dwordx4 v[112:115], v9, s[44:47], s11 offen offset:0 nt
    v_perm_b32 v30, v128, v128, v16
    v_perm_b32 v31, v128, v128, v17
    v_perm_b32 v34, v128, v128, v18
    v_perm_b32 v35, v128, v128, v19
    v_mfma_f32_16x16x32_bf16 v[40:43], v[80:83], v[30:33], v[40:43]
    v_mfma_f32_16x16x32_bf16 v[44:47], v[80:83], v[28:31], v[44:47]
    v_perm_b32 v30, v129, v129, v16
    v_perm_b32 v31, v129, v129, v17
    v_mfma_f32_16x16x32_bf16 v[40:43], v[84:87], v[34:37], v[40:43]
    v_mfma_f32_16x16x32_bf16 v[44:47], v[84:87], v[32:35], v[44:47]
    v_perm_b32 v34, v129, v129, v18
    v_perm_b32 v35, v129, v129, v19
    v_mfma_f32_16x16x32_bf16 v[40:43], v[88:91], v[30:33], v[40:43]
    v_mfma_f32_16x16x32_bf16 v[44:47], v[88:91], v[28:31], v[44:47]
    v_mfma_f32_16x16x32_bf16 v[40:43], v[92:95], v[34:37], v[40:43]
    v_mfma_f32_16x16x32_bf16 v[44:47], v[92:95], v[32:35], v[44:47]
    s_waitcnt vmcnt(3)
    s_bitcmp1_b32 s48, 0
    s_cbranch_scc1 L_bo61
    s_waitcnt vmcnt(2)
L_bo61:
    buffer_load_dwordx4 v[116:119], v9, s[44:47], s11 offen offset:1024 nt
    s_waitcnt vmcnt(3)
    s_bitcmp1_b32 s48, 0
    s_cbranch_scc1 L_bo62
    s_waitcnt vmcnt(2)
L_bo62:
    buffer_load_dwordx4 v[120:123], v9, s[44:47], s11 offen offset:2048 nt
    s_waitcnt vmcnt(3)
    s_bitcmp1_b32 s48, 0
    s_cbranch_scc1 L_bo63
    s_waitcnt vmcnt(2)
L_bo63:
    buffer_load_dwordx4 v[124:127], v9, s[44:47], s11 offen offset:3072 nt
    s_barrier
    s_cmp_lt_u32 s7, 14
    s_cbranch_scc0 L_late_bc
    s_add_u32 m0, s57, 41472
    s_nop 0
    global_load_lds_dwordx4 v162, s[32:33] nt
    v_add_u32 v162, 1024, v162
    s_add_u32 m0, s57, 42496
    s_nop 0
    global_load_lds_dwordx4 v162, s[32:33] nt
    s_mov_b64 exec, 1
    global_load_dword v163, v162, s[32:33]
    s_mov_b64 exec, 1
    global_load_dword v163, v162, s[32:33]
    s_branch L_late_donec
L_late_bc:
    s_cmp_ge_u32 s7, 16
    s_cselect_b64 exec, -1, 1
    s_add_u32 m0, s58, 8704
    s_nop 0
    global_load_lds_dwordx4 v160, s[24:25] offset:0 nt
    v_add_u32 v160, 0x2000, v160
    s_add_u32 m0, s58, 9728
    s_nop 0
    global_load_lds_dwordx4 v160, s[24:25] offset:0 nt
    v_add_u32 v160, 0x2000, v160
    s_add_u32 m0, s58, 10752
    s_nop 0
    global_load_lds_dwordx4 v160, s[24:25] offset:0 nt
    v_add_u32 v160, 0x2000, v160
    s_add_u32 m0, s58, 11776
    s_nop 0
    global_load_lds_dwordx4 v160, s[24:25] offset:0 nt
L_late_donec:
    s_mov_b64 exec, -1
    v_perm_b32 v30, v130, v130, v16
    v_perm_b32 v31, v130, v130, v17
    v_perm_b32 v34, v130, v130, v18
    v_perm_b32 v35, v130, v130, v19
    v_mfma_f32_16x16x32_bf16 v[40:43], v[96:99], v[30:33], v[40:43]
    v_mfma_f32_16x16x32_bf16 v[44:47], v[96:99], v[28:31], v[44:47]
    v_perm_b32 v30, v131, v131, v16
    v_perm_b32 v31, v131, v131, v17
    v_mfma_f32_16x16x32_bf16 v[40:43], v[100:103], v[34:37], v[40:43]
    v_mfma_f32_16x16x32_bf16 v[44:47], v[100:103], v[32:35], v[44:47]
    v_perm_b32 v34, v131, v131, v18
    v_perm_b32 v35, v131, v131, v19
    v_mfma_f32_16x16x32_bf16 v[40:43], v[104:107], v[30:33], v[40:43]
    v_mfma_f32_16x16x32_bf16 v[44:47], v[104:107], v[28:31], v[44:47]
    v_mfma_f32_16x16x32_bf16 v[40:43], v[108:111], v[34:37], v[40:43]
    v_mfma_f32_16x16x32_bf16 v[44:47], v[108:111], v[32:35], v[44:47]
    v_perm_b32 v30, v132, v132, v16
    v_perm_b32 v31, v132, v132, v17
    v_perm_b32 v34, v132, v132, v18
    v_perm_b32 v35, v132, v132, v19
    s_waitcnt vmcnt(7)
    v_mfma_f32_16x16x32_bf16 v[40:43], v[112:115], v[30:33], v[40:43]
    v_mfma_f32_16x16x32_bf16 v[44:47], v[112:115], v[28:31], v[44:47]
    v_perm_b32 v30, v133, v133, v16
    v_perm_b32 v31, v133, v133, v17
    s_waitcnt vmcnt(6)
    v_mfma_f32_16x16x32_bf16 v[40:43], v[116:119], v[34:37], v[40:43]
    v_mfma_f32_16x16x32_bf16 v[44:47], v[116:119], v[32:35], v[44:47]
    v_perm_b32 v34, v133, v133, v18
    v_perm_b32 v35, v133, v133, v19
    s_waitcnt vmcnt(5)
    v_mfma_f32_16x16x32_bf16 v[40:43], v[120:123], v[30:33], v[40:43]
    v_mfma_f32_16x16x32_bf16 v[44:47], v[120:123], v[28:31], v[44:47]
    s_waitcnt vmcnt(4)
    v_mfma_f32_16x16x32_bf16 v[40:43], v[124:127], v[34:37], v[40:43]
    v_mfma_f32_16x16x32_bf16 v[44:47], v[124:127], v[32:35], v[44:47]
    s_nop 6
    ds_write_b128 v64, v[40:43]
    ds_write_b128 v64, v[44:47] offset:1088
    s_waitcnt lgkmcnt(0)
    s_barrier
    ds_read_b32 v72, v65 offset:0
    ds_read_b32 v73, v65 offset:12288
    ds_read_b32 v74, v65 offset:24576
    ds_read_b32 v75, v65 offset:36864
    ds_read_b32 v76, v66 offset:0
    ds_read_b32 v77, v66 offset:12288
    ds_read_b32 v78, v66 offset:24576
    ds_read_b32 v79, v66 offset:36864
    s_cmp_eq_u32 s62, 1
    s_waitcnt lgkmcnt(0)
    v_pk_add_f32 v[72:73], v[72:73], v[76:77]
    v_pk_add_f32 v[74:75], v[74:75], v[78:79]
    v_pk_add_f32 v[72:73], v[72:73], v[74:75]
    v_add_f32 v72, v72, v73
    v_mul_f32 v72, v72, v15
    s_nop 1
    v_mov_b32_dpp v73, v72 quad_perm:[3,3,3,3] row_mask:0xf bank_mask:0xf
    v_perm_b32 v72, v72, v73, v10
    v_cndmask_b32 v72, v72, v12, s[50:51]
    s_cbranch_scc0 L_pubfar
    global_store_dword v67, v72, s[38:39]
L_published:
    s_cmp_lt_u32 s7, 14
    s_cbranch_scc1 L_ffn
    s_cmp_lt_u32 s7, 16
    s_cbranch_scc1 L_final
    s_barrier
    s_mov_b32 s59, 0
    global_load_dwordx4 v[120:123], v48, s[38:39] offset:0 sc1
    global_load_dwordx4 v[124:127], v49, s[38:39] offset:0 sc1
    global_load_dwordx4 v[128:131], v50, s[38:39] offset:0 sc1
    global_load_dwordx4 v[132:135], v51, s[38:39] offset:0 sc1
    s_waitcnt vmcnt(4)
    ds_read_b64_tr_b16 v[80:81], v52 offset:8704
    ds_read_b64_tr_b16 v[82:83], v52 offset:9216
    ds_read_b64_tr_b16 v[84:85], v52 offset:8736
    ds_read_b64_tr_b16 v[86:87], v52 offset:9248
    ds_read_b64_tr_b16 v[88:89], v52 offset:8768
    ds_read_b64_tr_b16 v[90:91], v52 offset:9280
    ds_read_b64_tr_b16 v[92:93], v52 offset:8800
    ds_read_b64_tr_b16 v[94:95], v52 offset:9312
    s_branch L_poll1_chk
L_poll1:
    global_load_dwordx4 v[120:123], v48, s[38:39] offset:0 sc1
    global_load_dwordx4 v[124:127], v49, s[38:39] offset:0 sc1
    global_load_dwordx4 v[128:131], v50, s[38:39] offset:0 sc1
    global_load_dwordx4 v[132:135], v51, s[38:39] offset:0 sc1
L_poll1_chk:
    s_waitcnt vmcnt(0)
    v_max_u32 v31, v120, v121
    v_max3_u32 v31, v31, v122, v123
    v_max3_u32 v31, v31, v124, v125
    v_max3_u32 v31, v31, v126, v127
    v_max3_u32 v31, v31, v128, v129
    v_max3_u32 v31, v31, v130, v131
    v_max3_u32 v31, v31, v132, v133
    v_max3_u32 v31, v31, v134, v135
    v_cmp_eq_u32 vcc, -1, v31
    s_cbranch_vccz L_poll1_ok
    s_add_u32 s59, s59, 1
    s_cmp_lt_u32 s59, 200000
    s_cbranch_scc0 L_poll1_ok
    s_mov_b64 exec, vcc
    s_sleep 1
    s_branch L_poll1
L_poll1_ok:
    s_mov_b64 exec, -1
    v_max3_f32 v16, v123, v127, v131
    v_max_f32 v16, v16, v135
    v_perm_b32 v152, v122, v121, s52
    v_perm_b32 v153, v126, v125, s52
    v_max_f32_dpp v16, v16, v16 row_ror:8 row_mask:0xf bank_mask:0xf
    v_mov_b32 v17, v16
    v_perm_b32 v154, v130, v129, s52
    v_perm_b32 v155, v134, v133, s52
    v_permlane16_swap_b32 v16, v17
    v_max_f32 v16, v16, v17
    v_mov_b32 v17, v16
    s_nop 1
    v_permlane32_swap_b32 v16, v17
    v_max_f32 v16, v16, v17
    v_sub_f32 v160, v123, v16
    v_sub_f32 v161, v127, v16
    v_sub_f32 v162, v131, v16
    v_sub_f32 v163, v135, v16
    v_exp_f32 v160, v160
    v_perm_b32 v123, v152, v120, s53
    v_exp_f32 v161, v161
    v_perm_b32 v127, v153, v124, s53
    v_exp_f32 v162, v162
    v_perm_b32 v131, v154, v128, s53
    v_exp_f32 v163, v163
    v_perm_b32 v135, v155, v132, s53
    v_pk_add_f32 v[16:17], v[160:161], v[162:163]
    v_pk_mul_f32 v[120:121], v[160:161], v[120:121] op_sel_hi:[0,1]
    v_pk_mul_f32 v[122:123], v[160:161], v[122:123] op_sel_hi:[0,1]
    v_add_f32 v16, v16, v17
    v_pk_fma_f32 v[120:121], v[160:161], v[124:125], v[120:121] op_sel:[1,0,0] op_sel_hi:[1,1,1]
    v_pk_fma_f32 v[122:123], v[160:161], v[126:127], v[122:123] op_sel:[1,0,0] op_sel_hi:[1,1,1]
    v_add_f32_dpp v16, v16, v16 row_ror:8 row_mask:0xf bank_mask:0xf
    v_pk_fma_f32 v[120:121], v[162:163], v[128:129], v[120:121] op_sel_hi:[0,1,1]
    v_pk_fma_f32 v[122:123], v[162:163], v[130:131], v[122:123] op_sel_hi:[0,1,1]
    v_pk_fma_f32 v[120:121], v[162:163], v[132:133], v[120:121] op_sel:[1,0,0] op_sel_hi:[1,1,1]
    v_pk_fma_f32 v[122:123], v[162:163], v[134:135], v[122:123] op_sel:[1,0,0] op_sel_hi:[1,1,1]
    v_mov_b32 v17, v16
    v_permlane32_swap_b32 v120, v121
    v_permlane32_swap_b32 v122, v123
    v_permlane32_swap_b32 v16, v17
    v_add_f32 v16, v16, v17
    v_mov_b32 v17, v16
    v_add_f32 v120, v120, v121
    v_add_f32 v122, v122, v123
    v_permlane16_swap_b32 v16, v17
    v_add_f32 v16, v16, v17
    v_permlane16_swap_b32 v120, v122
    v_rcp_f32 v16, v16
    v_add_f32 v120, v120, v122
    s_nop 1
    v_add_f32_dpp v120, v120, v120 row_ror:8 row_mask:0xf bank_mask:0xf
    v_mul_f32 v120, v120, v16
    s_nop 1
    v_mov_b32_dpp v121, v120 quad_perm:[1,0,3,2] row_mask:0xf bank_mask:0xf
    v_cvt_pk_bf16_f32 v120, v120, v121
    s_nop 1
    v_mov_b32_dpp v112, v120 row_newbcast:0 row_mask:0xf bank_mask:0xf
    v_mov_b32_dpp v113, v120 row_newbcast:2 row_mask:0xf bank_mask:0xf
    v_mov_b32_dpp v114, v120 row_newbcast:4 row_mask:0xf bank_mask:0xf
    v_mov_b32_dpp v115, v120 row_newbcast:6 row_mask:0xf bank_mask:0xf
    s_waitcnt lgkmcnt(0)
    s_nop 0
    v_mfma_f32_16x16x32_bf16 v[32:35], v[112:115], v[80:83], 0
    v_mfma_f32_16x16x32_bf16 v[36:39], v[112:115], v[84:87], 0
    v_mfma_f32_16x16x32_bf16 v[40:43], v[112:115], v[88:91], 0
    v_mfma_f32_16x16x32_bf16 v[44:47], v[112:115], v[92:95], 0
    s_nop 5
    v_cndmask_b32 v32, v32, v36, s[54:55]
    s_nop 0
    v_cndmask_b32 v40, v40, v44, s[54:55]
    v_cndmask_b32 v32, v32, v40, s[8:9]
    ds_write_b32 v53, v32 offset:2560
    s_cmp_eq_u32 s3, 0
    s_waitcnt lgkmcnt(0)
    s_barrier
    s_cbranch_scc0 L_bdone
    ds_read_b32 v120, v54 offset:2560
    ds_read_b32 v121, v54 offset:2816
    ds_read_b32 v122, v54 offset:3072
    ds_read_b32 v123, v54 offset:3328
    ds_read_b32 v124, v54 offset:3584
    ds_read_b32 v125, v54 offset:3840
    ds_read_b32 v126, v54 offset:4096
    ds_read_b32 v127, v54 offset:4352
    s_waitcnt lgkmcnt(0)
    v_pk_add_f32 v[120:121], v[120:121], v[124:125]
    v_pk_add_f32 v[122:123], v[122:123], v[126:127]
    v_pk_add_f32 v[120:121], v[120:121], v[122:123]
    v_add_f32 v120, v120, v121
    s_nop 1
    v_mov_b32_dpp v121, v120 quad_perm:[1,1,1,1] row_mask:0xf bank_mask:0xf
    v_mov_b32_dpp v122, v120 quad_perm:[2,2,2,2] row_mask:0xf bank_mask:0xf
    v_mov_b32_dpp v123, v120 quad_perm:[3,3,3,3] row_mask:0xf bank_mask:0xf
    s_mov_b32 exec_lo, 0x11111111
    s_mov_b32 exec_hi, 0x11111111
    global_store_dwordx4 v55, v[120:123], s[38:39] sc1
    global_store_dwordx4 v56, v[120:123], s[38:39] sc1
    s_mov_b64 exec, -1
L_bdone:
    s_endpgm
L_pubfar:
    s_nop 0
    v_mov_b32_dpp v73, v72 quad_perm:[1,1,1,1] row_mask:0xf bank_mask:0xf
    v_mov_b32_dpp v74, v72 quad_perm:[2,2,2,2] row_mask:0xf bank_mask:0xf
    v_mov_b32_dpp v75, v72 quad_perm:[3,3,3,3] row_mask:0xf bank_mask:0xf
    s_mov_b32 exec_lo, 0x11111111
    s_mov_b32 exec_hi, 0x11111111
    global_store_dwordx4 v67, v[72:75], s[38:39] sc1
    s_mov_b64 exec, -1
    s_branch L_published
L_ffn:
    v_and_b32 v17, 7, v0
    v_bfe_u32 v16, v0, 3, 2
    v_lshl_add_u32 v16, v17, 2, v16
    v_and_b32 v18, 32, v0
    v_add_u32 v16, v16, v18
    s_lshl_b32 s4, s3, 6
    v_add_u32 v65, s4, v16
    v_lshlrev_b32 v29, 1, v65
    ds_read_u16_d16_hi v64, v29 offset:1024
    s_lshl_b32 s4, s3, 8
    s_add_u32 s4, s4, 720896
    s_mov_b32 s5, s49
    s_add_u32 s4, s4, s5
    v_lshrrev_b32 v18, 4, v0
    v_lshlrev_b32 v19, 14, v18
    v_bfe_u32 v18, v0, 3, 1
    v_lshl_add_u32 v19, v18, 12, v19
    v_lshl_add_u32 v16, v17, 4, v19
    v_add_u32 v20, s4, v16
    v_lshrrev_b32 v18, 4, v0
    v_and_b32 v17, 15, v0
    s_lshr_b32 s5, s15, 2
    s_lshl_b32 s5, s5, 14
    s_and_b32 s4, s15, 3
    s_lshl_b32 s4, s4, 11
    s_add_u32 s4, s4, s5
    s_add_u32 s4, s4, 786432
    s_lshl_b32 s5, s3, 9
    s_and_b32 s5, s5, 0x7ff
    s_add_u32 s4, s4, s5
    s_mov_b32 s5, s49
    s_xor_b32 s5, s5, 0x2000
    s_add_u32 s4, s4, s5
    v_lshl_add_u32 v22, v0, 3, s4
    v_xor_b32 v21, 0x2000, v22
    s_lshl_b32 s5, s3, 4
    v_mov_b32 v23, s5
    v_and_b32 v24, 7, v0
    v_lshlrev_b32 v24, 4, v24
    s_mov_b32 s63, 0x42800000
    s_mov_b32 s54, 0xffff0000
    s_mov_b32 s55, 0xffff0000
    v_mov_b32 v67, 0x3b000000
    v_mov_b32 v68, 0x3727c5ac
    v_mov_b32 v69, 0xbdd2d3e8
    v_mov_b32 v70, 0xc0135761
    v_mov_b32 v72, 0x3f803f80
    v_mov_b32 v73, 0x3f803f80
    v_mov_b32 v74, 0x3f803f80
    v_mov_b32 v75, 0x3f803f80
    s_lshl_b32 s4, s3, 7
    v_lshl_add_u32 v25, v18, 4, s4
    v_lshlrev_b32 v27, 2, v0
    s_lshl_b32 s5, s3, 8
    v_add_u32 v26, s5, v27
    v_lshl_add_u32 v28, v0, 1, s4
    v_bfe_u32 v16, v0, 2, 2
    v_lshl_add_u32 v16, v18, 3, v16
    v_lshlrev_b32 v16, 5, v16
    v_and_b32 v17, 3, v0
    v_lshl_add_u32 v16, v17, 3, v16
    v_add_u32 v16, s57, v16
    s_waitcnt vmcnt(1)
    s_barrier
    s_lshl_b32 s5, s3, 8
    v_lshl_add_u32 v28, v0, 2, s5
    v_and_b32 v28, 0x3ff, v28
    ds_read_b32 v104, v28 offset:41472
    ds_read_b32 v105, v28 offset:42496
    ds_read_b32 v106, v28 offset:43520
    ds_read_b32 v107, v28 offset:44544
    ds_read_b32 v108, v28 offset:45568
    ds_read_b32 v109, v28 offset:46592
    ds_read_b32 v110, v28 offset:47616
    ds_read_b32 v111, v28 offset:48640
    ds_read_b32 v112, v28 offset:49664
    ds_read_b32 v113, v28 offset:50688
    ds_read_b32 v114, v28 offset:51712
    ds_read_b32 v115, v28 offset:52736
    ds_read_b32 v116, v28 offset:53760
    ds_read_b32 v117, v28 offset:54784
    s_waitcnt lgkmcnt(0)
    ds_read_b32 v118, v28 offset:55808
    ds_read_b32 v119, v28 offset:56832
    s_waitcnt lgkmcnt(0)
    v_and_b32 v40, 0xffff0000, v104
    v_lshlrev_b32 v104, 16, v104
    v_and_b32 v41, 0xffff0000, v105
    v_lshlrev_b32 v105, 16, v105
    v_and_b32 v42, 0xffff0000, v106
    v_lshlrev_b32 v106, 16, v106
    v_and_b32 v43, 0xffff0000, v107
    v_lshlrev_b32 v107, 16, v107
    v_and_b32 v44, 0xffff0000, v108
    v_lshlrev_b32 v108, 16, v108
    v_and_b32 v45, 0xffff0000, v109
    v_lshlrev_b32 v109, 16, v109
    v_and_b32 v46, 0xffff0000, v110
    v_lshlrev_b32 v110, 16, v110
    v_and_b32 v47, 0xffff0000, v111
    v_lshlrev_b32 v111, 16, v111
    v_and_b32 v48, 0xffff0000, v112
    v_lshlrev_b32 v112, 16, v112
    v_and_b32 v49, 0xffff0000, v113
    v_lshlrev_b32 v113, 16, v113
    v_and_b32 v50, 0xffff0000, v114
    v_lshlrev_b32 v114, 16, v114
    v_and_b32 v51, 0xffff0000, v115
    v_lshlrev_b32 v115, 16, v115
    v_and_b32 v52, 0xffff0000, v116
    v_lshlrev_b32 v116, 16, v116
    v_and_b32 v53, 0xffff0000, v117
    v_lshlrev_b32 v117, 16, v117
    v_and_b32 v54, 0xffff0000, v118
    v_lshlrev_b32 v118, 16, v118
    v_and_b32 v55, 0xffff0000, v119
    v_lshlrev_b32 v119, 16, v119
    s_waitcnt lgkmcnt(0)
    s_barrier
    s_mov_b32 s59, 0
    global_load_dwordx4 v[120:123], v20, s[38:39] offset:0 sc1
    global_load_dwordx4 v[124:127], v20, s[38:39] offset:128 sc1
    global_load_dwordx4 v[128:131], v20, s[38:39] offset:2048 sc1
    global_load_dwordx4 v[132:135], v20, s[38:39] offset:2176 sc1
    ds_read_b64_tr_b16 v[88:89], v16 offset:8704
    ds_read_b64_tr_b16 v[90:91], v16 offset:8832
    ds_read_b64_tr_b16 v[92:93], v16 offset:9728
    ds_read_b64_tr_b16 v[94:95], v16 offset:9856
    ds_read_b64_tr_b16 v[96:97], v16 offset:25088
    ds_read_b64_tr_b16 v[98:99], v16 offset:25216
    ds_read_b64_tr_b16 v[100:101], v16 offset:26112
    ds_read_b64_tr_b16 v[102:103], v16 offset:26240
    s_waitcnt lgkmcnt(0)
    v_mfma_f32_16x16x32_bf16 v[140:143], v[72:75], v[88:91], 0
    v_mfma_f32_16x16x32_bf16 v[144:147], v[72:75], v[96:99], 0
    v_mfma_f32_16x16x32_bf16 v[140:143], v[72:75], v[92:95], v[140:143]
    v_mfma_f32_16x16x32_bf16 v[144:147], v[72:75], v[100:103], v[144:147]
    s_nop 7
    v_cndmask_b32 v66, v140, v144, s[54:55]
    s_branch L_poll2_chk
L_poll2:
    global_load_dwordx4 v[120:123], v20, s[38:39] offset:0 sc1
    global_load_dwordx4 v[124:127], v20, s[38:39] offset:128 sc1
    global_load_dwordx4 v[128:131], v20, s[38:39] offset:2048 sc1
    global_load_dwordx4 v[132:135], v20, s[38:39] offset:2176 sc1
L_poll2_chk:
    s_waitcnt vmcnt(0)
    v_max_u32 v31, v120, v121
    v_max3_u32 v31, v31, v122, v123
    v_max3_u32 v31, v31, v124, v125
    v_max3_u32 v31, v31, v126, v127
    v_max3_u32 v31, v31, v128, v129
    v_max3_u32 v31, v31, v130, v131
    v_max3_u32 v31, v31, v132, v133
    v_max3_u32 v31, v31, v134, v135
    v_cmp_eq_u32 vcc, -1, v31
    s_cbranch_vccz L_poll2_ok
    s_add_u32 s59, s59, 1
    s_cmp_lt_u32 s59, 200000
    s_cbranch_scc0 L_poll2_ok
    s_mov_b64 exec, vcc
    s_sleep 1
    s_branch L_poll2
L_poll2_ok:
    s_mov_b64 exec, -1
    v_pk_add_f32 v[120:121], v[120:121], v[128:129]
    v_pk_add_f32 v[122:123], v[122:123], v[130:131]
    v_pk_add_f32 v[124:125], v[124:125], v[132:133]
    v_pk_add_f32 v[126:127], v[126:127], v[134:135]
    s_nop 0
    v_permlane32_swap_b32 v120, v124
    v_permlane32_swap_b32 v121, v125
    v_permlane32_swap_b32 v122, v126
    v_permlane32_swap_b32 v123, v127
    v_pk_add_f32 v[120:121], v[120:121], v[124:125]
    v_pk_add_f32 v[122:123], v[122:123], v[126:127]
    s_nop 1
    v_permlane16_swap_b32 v120, v122
    v_permlane16_swap_b32 v121, v123
    v_pk_add_f32 v[122:123], v[120:121], v[122:123]
    s_nop 1
    v_add_f32_dpp v120, v122, v122 row_ror:8 row_mask:0xf bank_mask:0x3
    s_nop 1
    v_add_f32_dpp v120, v123, v123 row_ror:8 row_mask:0xf bank_mask:0xc
    v_add_f32 v120, v120, v64
    v_cvt_pk_bf16_f32 v121, v120, v120
    ds_write_b16 v29, v121 offset:6656
    v_lshlrev_b32 v120, 16, v121
    s_nop 0
    v_readfirstlane_b32 s4, v120
    s_waitcnt lgkmcnt(0)
    ds_read_b128 v[124:127], v25 offset:6656
    ds_read_b128 v[128:131], v25 offset:6720
    v_subrev_f32 v148, s4, v120
    v_mov_b32 v150, s4
    v_mul_f32 v149, v148, v148
    v_add_f32_dpp v148, v148, v148 row_shr:1 row_mask:0xf bank_mask:0xf
    s_nop 0
    v_add_f32_dpp v149, v149, v149 row_shr:1 row_mask:0xf bank_mask:0xf
    v_add_f32_dpp v148, v148, v148 row_shr:2 row_mask:0xf bank_mask:0xf
    s_nop 0
    v_add_f32_dpp v149, v149, v149 row_shr:2 row_mask:0xf bank_mask:0xf
    s_waitcnt lgkmcnt(0)
    v_mfma_f32_16x16x32_bf16 v[132:135], v[124:127], v[88:91], 0
    v_mfma_f32_16x16x32_bf16 v[136:139], v[124:127], v[96:99], 0
    v_add_f32_dpp v148, v148, v148 row_shr:4 row_mask:0xf bank_mask:0xf
    v_add_f32_dpp v149, v149, v149 row_shr:4 row_mask:0xf bank_mask:0xf
    v_mfma_f32_16x16x32_bf16 v[132:135], v[128:131], v[92:95], v[132:135]
    v_mfma_f32_16x16x32_bf16 v[136:139], v[128:131], v[100:103], v[136:139]
    v_add_f32_dpp v148, v148, v148 row_shr:8 row_mask:0xf bank_mask:0xf
    v_add_f32_dpp v149, v149, v149 row_shr:8 row_mask:0xf bank_mask:0xf
    s_nop 0
    v_add_f32_dpp v148, v148, v148 row_bcast:15 row_mask:0xa bank_mask:0xf
    v_add_f32_dpp v149, v149, v149 row_bcast:15 row_mask:0xa bank_mask:0xf
    s_nop 0
    v_add_f32_dpp v148, v148, v148 row_bcast:31 row_mask:0xc bank_mask:0xf
    v_add_f32_dpp v149, v149, v149 row_bcast:31 row_mask:0xc bank_mask:0xf
    s_mov_b32 exec_lo, 0
    s_mov_b32 exec_hi, 0x80000000
    ds_write_b96 v23, v[148:150] offset:4608
    s_mov_b32 exec_lo, -1
    s_mov_b32 exec_hi, 0
    v_cndmask_b32 v66, v132, v136, s[54:55]
    s_mov_b64 exec, -1
    ds_write_b32 v26, v66 offset:2560
    s_waitcnt lgkmcnt(0)
    s_cmp_lt_u32 s3, 4
    s_barrier
    s_cbranch_scc0 L_cdone
    ds_read_b96 v[124:126], v24 offset:4608
    ds_read_b32 v128, v27 offset:2560
    ds_read_b32 v129, v27 offset:2816
    ds_read_b32 v130, v27 offset:3072
    ds_read_b32 v131, v27 offset:3328
    ds_read_b32 v132, v27 offset:3584
    ds_read_b32 v133, v27 offset:3840
    ds_read_b32 v134, v27 offset:4096
    ds_read_b32 v135, v27 offset:4352
    s_waitcnt lgkmcnt(8)
    v_fma_f32 v127, v126, s63, v124
    v_add_f32 v124, v124, v124
    s_waitcnt lgkmcnt(4)
    v_add_f32_dpp v127, v127, v127 quad_perm:[1,0,3,2] row_mask:0xf bank_mask:0xf
    v_pk_add_f32 v[128:129], v[128:129], v[130:131]
    s_waitcnt lgkmcnt(0)
    v_add_f32_dpp v127, v127, v127 quad_perm:[2,3,0,1] row_mask:0xf bank_mask:0xf
    v_pk_add_f32 v[132:133], v[132:133], v[134:135]
    v_pk_add_f32 v[128:129], v[128:129], v[132:133]
    v_add_f32_dpp v127, v127, v127 row_half_mirror row_mask:0xf bank_mask:0xf
    v_add_f32 v120, v128, v129
    v_add_f32 v121, v128, v129
    v_mul_f32 v127, 0x3b000000, v127
    v_sub_f32 v126, v127, v126
    v_permlane32_swap_b32 v120, v121
    v_fma_f32 v124, v126, s63, -v124
    v_fma_f32 v125, v126, v124, v125
    v_fma_f32 v122, -v127, v121, v120
    v_fma_f32 v121, -v127, v121, v120
    v_add_f32_dpp v125, v125, v125 quad_perm:[1,0,3,2] row_mask:0xf bank_mask:0xf
    v_mov_b32 v120, v122
    s_nop 0
    v_add_f32_dpp v125, v125, v125 quad_perm:[2,3,0,1] row_mask:0xf bank_mask:0xf
    v_permlane16_swap_b32 v120, v121
    s_nop 0
    v_add_f32_dpp v125, v125, v125 row_half_mirror row_mask:0xf bank_mask:0xf
    v_fma_f32 v125, v125, v67, v68
    v_rsq_f32 v125, v125
    s_nop 0
    v_mul_f32 v120, v120, v125
    v_mul_f32 v121, v121, v125
    v_mul_f32 v122, v120, v120
    v_mul_f32 v121, v120, v121
    v_fma_f32 v122, v122, v69, v70
    v_mul_f32 v122, v122, v120
    v_exp_f32 v122, v122
    s_nop 0
    v_add_f32 v122, 1.0, v122
    v_rcp_f32 v122, v122
    s_nop 0
    v_mul_f32 v120, v121, v122
    s_nop 1
    v_mul_f32_dpp v124, v120, v104 row_newbcast:0 row_mask:0xf bank_mask:0xf
    v_mul_f32_dpp v125, v120, v40 row_newbcast:0 row_mask:0xf bank_mask:0xf
    v_mul_f32_dpp v126, v120, v105 row_newbcast:1 row_mask:0xf bank_mask:0xf
    v_mul_f32_dpp v127, v120, v41 row_newbcast:1 row_mask:0xf bank_mask:0xf
    v_fmac_f32_dpp v124, v120, v106 row_newbcast:2 row_mask:0xf bank_mask:0xf
    v_fmac_f32_dpp v125, v120, v42 row_newbcast:2 row_mask:0xf bank_mask:0xf
    v_fmac_f32_dpp v126, v120, v107 row_newbcast:3 row_mask:0xf bank_mask:0xf
    v_fmac_f32_dpp v127, v120, v43 row_newbcast:3 row_mask:0xf bank_mask:0xf
    v_fmac_f32_dpp v124, v120, v108 row_newbcast:4 row_mask:0xf bank_mask:0xf
    v_fmac_f32_dpp v125, v120, v44 row_newbcast:4 row_mask:0xf bank_mask:0xf
    v_fmac_f32_dpp v126, v120, v109 row_newbcast:5 row_mask:0xf bank_mask:0xf
    v_fmac_f32_dpp v127, v120, v45 row_newbcast:5 row_mask:0xf bank_mask:0xf
    v_fmac_f32_dpp v124, v120, v110 row_newbcast:6 row_mask:0xf bank_mask:0xf
    v_fmac_f32_dpp v125, v120, v46 row_newbcast:6 row_mask:0xf bank_mask:0xf
    v_fmac_f32_dpp v126, v120, v111 row_newbcast:7 row_mask:0xf bank_mask:0xf
    v_fmac_f32_dpp v127, v120, v47 row_newbcast:7 row_mask:0xf bank_mask:0xf
    v_fmac_f32_dpp v124, v120, v112 row_newbcast:8 row_mask:0xf bank_mask:0xf
    v_fmac_f32_dpp v125, v120, v48 row_newbcast:8 row_mask:0xf bank_mask:0xf
    v_fmac_f32_dpp v126, v120, v113 row_newbcast:9 row_mask:0xf bank_mask:0xf
    v_fmac_f32_dpp v127, v120, v49 row_newbcast:9 row_mask:0xf bank_mask:0xf
    v_fmac_f32_dpp v124, v120, v114 row_newbcast:10 row_mask:0xf bank_mask:0xf
    v_fmac_f32_dpp v125, v120, v50 row_newbcast:10 row_mask:0xf bank_mask:0xf
    v_fmac_f32_dpp v126, v120, v115 row_newbcast:11 row_mask:0xf bank_mask:0xf
    v_fmac_f32_dpp v127, v120, v51 row_newbcast:11 row_mask:0xf bank_mask:0xf
    v_fmac_f32_dpp v124, v120, v116 row_newbcast:12 row_mask:0xf bank_mask:0xf
    v_fmac_f32_dpp v125, v120, v52 row_newbcast:12 row_mask:0xf bank_mask:0xf
    v_fmac_f32_dpp v126, v120, v117 row_newbcast:13 row_mask:0xf bank_mask:0xf
    v_fmac_f32_dpp v127, v120, v53 row_newbcast:13 row_mask:0xf bank_mask:0xf
    v_fmac_f32_dpp v124, v120, v118 row_newbcast:14 row_mask:0xf bank_mask:0xf
    v_fmac_f32_dpp v125, v120, v54 row_newbcast:14 row_mask:0xf bank_mask:0xf
    v_fmac_f32_dpp v126, v120, v119 row_newbcast:15 row_mask:0xf bank_mask:0xf
    v_fmac_f32_dpp v127, v120, v55 row_newbcast:15 row_mask:0xf bank_mask:0xf
    v_pk_add_f32 v[124:125], v[124:125], v[126:127]
    s_nop 1
    v_mov_b32_dpp v126, v124 quad_perm:[1,1,3,3] row_mask:0xf bank_mask:0xf
    v_mov_b32_dpp v127, v125 quad_perm:[1,1,3,3] row_mask:0xf bank_mask:0xf
    s_mov_b32 exec_lo, 0x55555555
    s_mov_b32 exec_hi, 0x55555555
    global_store_dwordx4 v22, v[124:127], s[38:39] sc1
    global_store_dwordx4 v21, v[124:127], s[38:39] sc1
    s_mov_b64 exec, -1
L_cdone:
    s_endpgm
L_final:
    s_barrier
    s_sub_u32 s15, s7, 14
    s_lshl_b32 s4, s6, 1
    s_add_u32 s15, s15, s4
    v_and_b32 v16, 7, v0
    v_lshrrev_b32 v17, 3, v0
    v_lshlrev_b32 v17, 11, v17
    v_lshl_add_u32 v17, v16, 4, v17
    v_and_b32 v22, 31, v0
    s_lshl_b32 s4, s15, 6
    v_lshl_add_u32 v18, v22, 1, s4
    v_lshlrev_b32 v22, 2, v22
    v_bfe_u32 v23, v0, 4, 1
    v_lshrrev_b32 v24, 5, v0
    v_lshl_add_u32 v23, v23, 1, v24
    v_lshl_add_u32 v23, v16, 2, v23
    v_lshl_add_u32 v19, v23, 1, s4
    ds_read_u16_d16_hi v19, v19 offset:1024
    s_lshl_b32 s4, s3, 7
    v_lshl_add_u32 v23, v23, 2, s4
    v_lshrrev_b32 v24, 5, v0
    v_lshlrev_b32 v24, 13, v24
    s_mov_b32 s8, s49
    s_lshl_b32 s4, s3, 16
    s_add_u32 s4, s4, 786432
    s_cmp_eq_u32 s3, 7
    s_cselect_b32 s4, 720896, s4
    s_add_u32 s4, s4, s8
    s_mov_b32 s9, 0x8000
    s_lshl_b32 s5, s15, 7
    s_add_u32 s4, s4, s5
    v_add3_u32 v20, v17, v24, s4
    v_add_u32 v21, s9, v20
    s_mov_b32 s59, 0
L_poll3:
    global_load_dwordx4 v[120:123], v20, s[38:39] sc1
    global_load_dwordx4 v[124:127], v21, s[38:39] sc1
    s_waitcnt vmcnt(0)
    v_max_u32 v16, v120, v121
    v_max3_u32 v16, v16, v122, v123
    v_max3_u32 v16, v16, v124, v125
    v_max3_u32 v16, v16, v126, v127
    v_cmp_eq_u32 vcc, -1, v16
    s_cbranch_vccz L_poll3_ok
    s_add_u32 s59, s59, 1
    s_cmp_lt_u32 s59, 200000
    s_cbranch_scc0 L_poll3_ok
    s_mov_b64 exec, vcc
    s_sleep 1
    s_branch L_poll3
L_poll3_ok:
    s_mov_b64 exec, -1
    v_add_f32 v120, v120, v124
    v_add_f32 v121, v121, v125
    v_add_f32 v122, v122, v126
    v_add_f32 v123, v123, v127
    v_permlane32_swap_b32 v120, v121
    s_nop 0
    v_permlane32_swap_b32 v122, v123
    v_add_f32 v120, v120, v121
    v_add_f32 v122, v122, v123
    s_nop 1
    v_permlane16_swap_b32 v120, v122
    v_add_f32 v120, v120, v122
    s_nop 1
    v_add_f32_dpp v120, v120, v120 row_ror:8 row_mask:0xf bank_mask:0xf
    s_cmp_eq_u32 s3, 7
    s_cbranch_scc0 L_dnoh
    s_waitcnt lgkmcnt(0)
    v_add_f32 v120, v120, v19
    v_cvt_pk_bf16_f32 v120, v120, v120
    v_lshlrev_b32 v120, 16, v120
L_dnoh:
    s_mov_b32 exec_lo, 0x00ff00ff
    s_mov_b32 exec_hi, 0x00ff00ff
    ds_write_b32 v23, v120 offset:2560
    s_mov_b64 exec, -1
    s_cmp_eq_u32 s3, 0
    s_waitcnt lgkmcnt(0)
    s_barrier
    s_cbranch_scc0 L_ddone
    ds_read_b32 v120, v22 offset:2560
    ds_read_b32 v121, v22 offset:2688
    ds_read_b32 v122, v22 offset:2816
    ds_read_b32 v123, v22 offset:2944
    ds_read_b32 v124, v22 offset:3072
    ds_read_b32 v125, v22 offset:3200
    ds_read_b32 v126, v22 offset:3328
    ds_read_b32 v127, v22 offset:3456
    s_waitcnt lgkmcnt(0)
    v_pk_add_f32 v[120:121], v[120:121], v[124:125]
    v_pk_add_f32 v[122:123], v[122:123], v[126:127]
    v_pk_add_f32 v[120:121], v[120:121], v[122:123]
    v_add_f32 v120, v120, v121
    s_nop 1
    v_mov_b32_dpp v121, v120 quad_perm:[1,0,3,2] row_mask:0xf bank_mask:0xf
    v_cvt_pk_bf16_f32 v120, v120, v121
    s_mov_b64 exec, 0x55555555
    global_store_dword v18, v120, s[34:35]
L_ddone:
    s_endpgm
L_service:
    s_setprio 3
    v_mov_b32 v98, 2304
    v_mov_b32 v99, 0
    ds_write_b32 v98, v99
    ds_write_b32 v98, v99 offset:8
    ds_write_b32 v98, v99 offset:12
    ds_write_b32 v98, v99 offset:20
    v_mov_b32 v100, -1
    v_mov_b32 v101, -1
    v_mov_b32 v102, -1
    v_mov_b32 v103, -1
    s_add_u32 s61, s6, 0
    s_and_b32 s61, s61, 7
    s_bfe_u32 s13, s7, 0x10003
    s_lshl_b32 s4, s61, 1
    s_add_u32 s13, s13, s4
    s_and_b32 s14, s7, 7
    s_mul_i32 s15, s6, 14
    s_add_u32 s15, s15, s7
    s_lshl_b32 s4, s6, 5
    s_add_u32 s4, s4, s7
    s_mul_i32 s4, s4, 2048
    s_add_u32 s4, s4, 131072
    v_add_u32 v104, s4, v9
    s_cmp_eq_u32 s7, 0
    s_waitcnt lgkmcnt(0)
    s_cbranch_scc0 L_qcleared
    s_lshl_b32 s10, s60, 13
    v_add_u32 v3, s10, v9
    v_add_u32 v8, 0x1000, v3
    global_store_dwordx4 v3, v[100:103], s[38:39] offset:0 sc1
    global_store_dwordx4 v3, v[100:103], s[38:39] offset:1024 sc1
    global_store_dwordx4 v3, v[100:103], s[38:39] offset:2048 sc1
    global_store_dwordx4 v3, v[100:103], s[38:39] offset:3072 sc1
    global_store_dwordx4 v8, v[100:103], s[38:39] offset:0 sc1
    global_store_dwordx4 v8, v[100:103], s[38:39] offset:1024 sc1
    global_store_dwordx4 v8, v[100:103], s[38:39] offset:2048 sc1
    global_store_dwordx4 v8, v[100:103], s[38:39] offset:3072 sc1
    s_lshl_b32 s10, s60, 7
    s_add_u32 s10, s10, 65536
    v_add_u32 v3, s10, v9
    s_lshl_b32 s10, s6, 7
    s_add_u32 s10, s10, 69632
    v_add_u32 v8, s10, v9
    s_mov_b64 exec, 0xff
    global_store_dwordx4 v3, v[100:103], s[38:39] sc1
    global_store_dwordx4 v8, v[100:103], s[38:39] sc1
    v_add_u32 v8, 4096, v8
    global_store_dwordx4 v8, v[100:103], s[38:39] sc1
    v_add_u32 v8, 4096, v8
    global_store_dwordx4 v8, v[100:103], s[38:39] sc1
    s_mov_b64 exec, -1
L_qcleared:
    s_barrier
    v_lshlrev_b32 v96, 5, v0
    s_cmp_eq_u32 s7, 0
    s_cbranch_scc0 L_noqflag
    s_lshl_b32 s4, s60, 5
    v_mov_b32 v104, s4
    v_mov_b32 v105, 1
    s_waitcnt vmcnt(0)
    s_mov_b64 exec, 1
    global_store_dword v104, v105, s[36:37] sc1
    s_mov_b64 exec, -1
L_noqflag:
    v_mov_b32 v24, 2304
    s_mov_b32 s5, 0
L_waitwq:
    ds_read_b32 v25, v24 offset:12
    s_waitcnt lgkmcnt(0)
    v_cmp_eq_u32 vcc, 8, v25
    s_cbranch_vccnz L_waitwq_ok
    s_add_u32 s5, s5, 1
    s_cmp_lt_u32 s5, 12800000
    s_cbranch_scc0 L_waitwq_ok
    s_sleep 1
    s_branch L_waitwq
L_waitwq_ok:
    s_mov_b64 exec, 0xff
    global_load_dword v97, v96, s[36:37] sc1
    s_mov_b64 exec, -1
    ds_read_b128 v[4:7], v9 offset:1024
    s_waitcnt lgkmcnt(0)
    v_lshlrev_b32 v8, 16, v4
    v_and_b32 v3, 0xffff0000, v4
    v_lshlrev_b32 v10, 16, v5
    v_and_b32 v11, 0xffff0000, v5
    v_lshlrev_b32 v12, 16, v6
    v_and_b32 v13, 0xffff0000, v6
    v_lshlrev_b32 v14, 16, v7
    v_and_b32 v15, 0xffff0000, v7
    v_add_f32 v19, v8, v3
    v_add_f32 v20, v10, v11
    v_add_f32 v16, v12, v13
    v_add_f32 v17, v14, v15
    v_add_f32 v19, v19, v20
    v_add_f32 v16, v16, v17
    v_add_f32 v16, v16, v19
    s_nop 1
    v_add_f32_dpp v16, v16, v16 row_ror:8 row_mask:0xf bank_mask:0xf
    s_nop 1
    v_add_f32_dpp v16, v16, v16 row_ror:4 row_mask:0xf bank_mask:0xf
    s_nop 1
    v_add_f32_dpp v16, v16, v16 row_ror:2 row_mask:0xf bank_mask:0xf
    s_nop 1
    v_add_f32_dpp v16, v16, v16 row_ror:1 row_mask:0xf bank_mask:0xf
    v_mov_b32 v19, v16
    s_nop 1
    v_permlane16_swap_b32 v16, v19
    v_add_f32 v16, v16, v19
    v_mov_b32 v19, v16
    s_nop 1
    v_permlane32_swap_b32 v16, v19
    v_add_f32 v16, v16, v19
    v_mul_f32 v16, 0x3b000000, v16
    v_sub_f32 v22, v8, v16
    v_sub_f32 v23, v3, v16
    v_sub_f32 v24, v10, v16
    v_sub_f32 v25, v11, v16
    v_sub_f32 v26, v12, v16
    v_sub_f32 v27, v13, v16
    v_sub_f32 v28, v14, v16
    v_sub_f32 v29, v15, v16
    v_mul_f32 v17, v22, v22
    v_mul_f32 v20, v23, v23
    v_fmac_f32 v17, v24, v24
    v_fmac_f32 v20, v25, v25
    v_fmac_f32 v17, v26, v26
    v_fmac_f32 v20, v27, v27
    v_fmac_f32 v17, v28, v28
    v_fmac_f32 v20, v29, v29
    v_add_f32 v17, v17, v20
    s_nop 1
    v_add_f32_dpp v17, v17, v17 row_ror:8 row_mask:0xf bank_mask:0xf
    s_nop 1
    v_add_f32_dpp v17, v17, v17 row_ror:4 row_mask:0xf bank_mask:0xf
    s_nop 1
    v_add_f32_dpp v17, v17, v17 row_ror:2 row_mask:0xf bank_mask:0xf
    s_nop 1
    v_add_f32_dpp v17, v17, v17 row_ror:1 row_mask:0xf bank_mask:0xf
    v_mov_b32 v19, v17
    s_nop 1
    v_permlane16_swap_b32 v17, v19
    v_add_f32 v17, v17, v19
    v_mov_b32 v19, v17
    s_nop 1
    v_permlane32_swap_b32 v17, v19
    v_add_f32 v17, v17, v19
    v_mul_f32 v17, 0x3b000000, v17
    v_cvt_pk_bf16_f32 v19, v16, v17
    v_lshlrev_b32 v16, 16, v19
    v_and_b32 v17, 0xffff0000, v19
    v_add_f32 v17, 0x3727c5ac, v17
    v_cvt_pk_bf16_f32 v17, v17, v17
    v_lshlrev_b32 v17, 16, v17
    v_sqrt_f32 v19, v17
    v_rsq_f32 v20, v17
    v_fma_f32 v17, -v19, v19, v17
    v_mul_f32 v20, 0.5, v20
    v_fma_f32 v17, v17, v20, v19
    v_cvt_pk_bf16_f32 v17, v17, v17
    v_lshlrev_b32 v17, 16, v17
    v_rcp_f32 v18, v17
    v_sub_f32 v8, v8, v16
    v_sub_f32 v3, v3, v16
    v_sub_f32 v10, v10, v16
    v_sub_f32 v11, v11, v16
    v_sub_f32 v12, v12, v16
    v_sub_f32 v13, v13, v16
    v_sub_f32 v14, v14, v16
    v_sub_f32 v15, v15, v16
    v_cvt_pk_bf16_f32 v8, v8, v8
    v_cvt_pk_bf16_f32 v3, v3, v3
    v_cvt_pk_bf16_f32 v10, v10, v10
    v_cvt_pk_bf16_f32 v11, v11, v11
    v_cvt_pk_bf16_f32 v12, v12, v12
    v_cvt_pk_bf16_f32 v13, v13, v13
    v_cvt_pk_bf16_f32 v14, v14, v14
    v_cvt_pk_bf16_f32 v15, v15, v15
    v_lshlrev_b32 v8, 16, v8
    v_lshlrev_b32 v3, 16, v3
    v_lshlrev_b32 v10, 16, v10
    v_lshlrev_b32 v11, 16, v11
    v_lshlrev_b32 v12, 16, v12
    v_lshlrev_b32 v13, 16, v13
    v_lshlrev_b32 v14, 16, v14
    v_lshlrev_b32 v15, 16, v15
    v_mul_f32 v22, v8, v18
    v_mul_f32 v23, v3, v18
    v_mul_f32 v24, v10, v18
    v_mul_f32 v25, v11, v18
    v_mul_f32 v26, v12, v18
    v_mul_f32 v27, v13, v18
    v_mul_f32 v28, v14, v18
    v_mul_f32 v29, v15, v18
    v_fma_f32 v8, -v22, v17, v8
    v_fma_f32 v3, -v23, v17, v3
    v_fma_f32 v10, -v24, v17, v10
    v_fma_f32 v11, -v25, v17, v11
    v_fma_f32 v12, -v26, v17, v12
    v_fma_f32 v13, -v27, v17, v13
    v_fma_f32 v14, -v28, v17, v14
    v_fma_f32 v15, -v29, v17, v15
    v_fma_f32 v8, v8, v18, v22
    v_fma_f32 v3, v3, v18, v23
    v_fma_f32 v10, v10, v18, v24
    v_fma_f32 v11, v11, v18, v25
    v_fma_f32 v12, v12, v18, v26
    v_fma_f32 v13, v13, v18, v27
    v_fma_f32 v14, v14, v18, v28
    v_fma_f32 v15, v15, v18, v29
    v_cvt_pk_bf16_f32 v4, v8, v3
    v_cvt_pk_bf16_f32 v5, v10, v11
    v_cvt_pk_bf16_f32 v6, v12, v13
    v_cvt_pk_bf16_f32 v7, v14, v15
    ds_write_b128 v9, v[4:7] offset:6656
    s_and_b32 s4, s7, 3
    s_lshl_b32 s4, s4, 8
    v_lshrrev_b32 v17, 4, v0
    v_lshl_add_u32 v16, v17, 4, s4
    v_bfe_u32 v18, v0, 2, 2
    v_lshl_add_u32 v17, v17, 3, v18
    v_lshlrev_b32 v17, 7, v17
    v_and_b32 v18, 3, v0
    v_lshl_add_u32 v17, v18, 3, v17
    s_waitcnt lgkmcnt(0)
    ds_read_b128 v[32:35], v16 offset:6656
    ds_read_b128 v[36:39], v16 offset:6720
    ds_read_b128 v[40:43], v16 offset:6784
    ds_read_b128 v[44:47], v16 offset:6848
    s_waitcnt lgkmcnt(0)
    ds_read_b64_tr_b16 v[64:65], v17 offset:8704
    ds_read_b64_tr_b16 v[66:67], v17 offset:9216
    ds_read_b64_tr_b16 v[68:69], v17 offset:8736
    ds_read_b64_tr_b16 v[70:71], v17 offset:9248
    ds_read_b64_tr_b16 v[72:73], v17 offset:8768
    ds_read_b64_tr_b16 v[74:75], v17 offset:9280
    ds_read_b64_tr_b16 v[76:77], v17 offset:8800
    ds_read_b64_tr_b16 v[78:79], v17 offset:9312
    s_waitcnt lgkmcnt(0)
    ds_read_b64_tr_b16 v[80:81], v17 offset:12800
    ds_read_b64_tr_b16 v[82:83], v17 offset:13312
    ds_read_b64_tr_b16 v[84:85], v17 offset:12832
    ds_read_b64_tr_b16 v[86:87], v17 offset:13344
    ds_read_b64_tr_b16 v[88:89], v17 offset:12864
    ds_read_b64_tr_b16 v[90:91], v17 offset:13376
    ds_read_b64_tr_b16 v[92:93], v17 offset:12896
    ds_read_b64_tr_b16 v[94:95], v17 offset:13408
    v_mfma_f32_16x16x32_bf16 v[112:115], v[32:35], v[64:67], 0
    v_mfma_f32_16x16x32_bf16 v[116:119], v[32:35], v[68:71], 0
    v_mfma_f32_16x16x32_bf16 v[120:123], v[32:35], v[72:75], 0
    v_mfma_f32_16x16x32_bf16 v[124:127], v[32:35], v[76:79], 0
    s_waitcnt lgkmcnt(0)
    ds_read_b64_tr_b16 v[64:65], v17 offset:16896
    ds_read_b64_tr_b16 v[66:67], v17 offset:17408
    ds_read_b64_tr_b16 v[68:69], v17 offset:16928
    ds_read_b64_tr_b16 v[70:71], v17 offset:17440
    ds_read_b64_tr_b16 v[72:73], v17 offset:16960
    ds_read_b64_tr_b16 v[74:75], v17 offset:17472
    ds_read_b64_tr_b16 v[76:77], v17 offset:16992
    ds_read_b64_tr_b16 v[78:79], v17 offset:17504
    v_mfma_f32_16x16x32_bf16 v[112:115], v[36:39], v[80:83], v[112:115]
    v_mfma_f32_16x16x32_bf16 v[116:119], v[36:39], v[84:87], v[116:119]
    v_mfma_f32_16x16x32_bf16 v[120:123], v[36:39], v[88:91], v[120:123]
    v_mfma_f32_16x16x32_bf16 v[124:127], v[36:39], v[92:95], v[124:127]
    s_waitcnt lgkmcnt(0)
    ds_read_b64_tr_b16 v[80:81], v17 offset:20992
    ds_read_b64_tr_b16 v[82:83], v17 offset:21504
    ds_read_b64_tr_b16 v[84:85], v17 offset:21024
    ds_read_b64_tr_b16 v[86:87], v17 offset:21536
    ds_read_b64_tr_b16 v[88:89], v17 offset:21056
    ds_read_b64_tr_b16 v[90:91], v17 offset:21568
    ds_read_b64_tr_b16 v[92:93], v17 offset:21088
    ds_read_b64_tr_b16 v[94:95], v17 offset:21600
    v_mfma_f32_16x16x32_bf16 v[112:115], v[40:43], v[64:67], v[112:115]
    v_mfma_f32_16x16x32_bf16 v[116:119], v[40:43], v[68:71], v[116:119]
    v_mfma_f32_16x16x32_bf16 v[120:123], v[40:43], v[72:75], v[120:123]
    v_mfma_f32_16x16x32_bf16 v[124:127], v[40:43], v[76:79], v[124:127]
    s_waitcnt lgkmcnt(0)
    v_mfma_f32_16x16x32_bf16 v[112:115], v[44:47], v[80:83], v[112:115]
    v_mfma_f32_16x16x32_bf16 v[116:119], v[44:47], v[84:87], v[116:119]
    v_mfma_f32_16x16x32_bf16 v[120:123], v[44:47], v[88:91], v[120:123]
    v_mfma_f32_16x16x32_bf16 v[124:127], v[44:47], v[92:95], v[124:127]
    s_lshl_b32 s4, s60, 13
    s_and_b32 s5, s7, 3
    s_lshl_b32 s5, s5, 11
    s_add_u32 s4, s4, s5
    s_lshr_b32 s5, s7, 2
    s_lshl_b32 s5, s5, 8
    s_add_u32 s4, s4, s5
    v_lshl_add_u32 v17, v0, 2, s4
    v_mov_b32_dpp v112, v116 quad_perm:[0,1,2,3] row_mask:0x2 bank_mask:0xf
    s_nop 1
    v_mov_b32_dpp v112, v120 quad_perm:[0,1,2,3] row_mask:0x4 bank_mask:0xf
    s_nop 1
    v_mov_b32_dpp v112, v124 quad_perm:[0,1,2,3] row_mask:0x8 bank_mask:0xf
    s_nop 1
    v_mov_b32_dpp v113, v112 quad_perm:[1,1,1,1] row_mask:0xf bank_mask:0xf
    v_mov_b32_dpp v114, v112 quad_perm:[2,2,2,2] row_mask:0xf bank_mask:0xf
    v_mov_b32_dpp v115, v112 quad_perm:[3,3,3,3] row_mask:0xf bank_mask:0xf
L_qdone:
    s_lshl_b32 s4, s60, 5
    s_add_u32 s4, s4, s7
    s_lshl_b32 s4, s4, 2
    s_add_u32 s4, s4, 65536
    v_mov_b32 v18, s4
    s_lshl_b32 s4, s6, 13
    v_add_u32 v19, s4, v9
    v_add_u32 v20, 0x1000, v19
    s_getreg_b32 s62, hwreg(HW_REG_XCC_ID, 0, 4)
    v_mov_b32 v21, s62
    s_lshl_b32 s4, 1, s60
    s_lshl_b32 s5, 1, s6
    s_or_b32 s4, s4, s5
    s_mov_b32 s5, 0
L_pollf:
    s_waitcnt vmcnt(0) lgkmcnt(0)
    v_cmp_ne_u32 vcc, 1, v97
    s_nop 0
    s_and_b32 s57, vcc_lo, s4
    s_cbranch_scc0 L_pollf_ok
    s_add_u32 s5, s5, 1
    s_cmp_lt_u32 s5, 200000
    s_cbranch_scc0 L_pollf_ok
    s_sleep 8
    s_mov_b64 exec, 0xff
    global_load_dword v97, v96, s[36:37] sc1
    s_mov_b64 exec, -1
    s_branch L_pollf
L_pollf_ok:
    s_mov_b32 exec_lo, 0x11111111
    s_mov_b32 exec_hi, 0x11111111
    global_store_dwordx4 v17, v[112:115], s[38:39] sc1
L_noqpub:
    s_mov_b64 exec, 1
    global_store_dword v18, v21, s[38:39] sc1
    s_mov_b64 exec, -1
    s_getpc_b64 s[48:49]
L_pc:
    s_sub_u32 s48, s48, L_pc-sequential_preLN__gqa_block_cached__glu_gated_geglu__decode_kernel
    s_subb_u32 s49, s49, 0
    s_lshl_b32 s4, s7, 9
    v_lshl_add_u32 v2, v0, 3, s4
    v_min_u32 v2, L_codeend-sequential_preLN__gqa_block_cached__glu_gated_geglu__decode_kernel-8, v2
    global_load_dwordx2 v[128:129], v2, s[48:49]
L_nowarm:
    v_mov_b32 v24, 2304
    s_mov_b32 s5, 0
L_waitpos:
    ds_read_b32 v25, v24 offset:8
    s_waitcnt lgkmcnt(0)
    v_cmp_ne_u32 vcc, 0, v25
    s_cbranch_vccnz L_waitpos_ok
    s_add_u32 s5, s5, 1
    s_cmp_lt_u32 s5, 12800000
    s_cbranch_scc0 L_waitpos_ok
    s_sleep 1
    s_branch L_waitpos
L_waitpos_ok:
    s_mov_b32 s59, 0
L_pollq:
    global_load_dwordx4 v[32:35], v19, s[38:39] offset:0 sc1
    global_load_dwordx4 v[36:39], v19, s[38:39] offset:1024 sc1
    global_load_dwordx4 v[40:43], v19, s[38:39] offset:2048 sc1
    global_load_dwordx4 v[44:47], v19, s[38:39] offset:3072 sc1
    global_load_dwordx4 v[48:51], v20, s[38:39] offset:0 sc1
    global_load_dwordx4 v[52:55], v20, s[38:39] offset:1024 sc1
    global_load_dwordx4 v[56:59], v20, s[38:39] offset:2048 sc1
    global_load_dwordx4 v[60:63], v20, s[38:39] offset:3072 sc1
    s_waitcnt vmcnt(0)
    v_max_u32 v16, v32, v33
    v_max3_u32 v16, v16, v34, v35
    v_max3_u32 v16, v16, v36, v37
    v_max3_u32 v16, v16, v38, v39
    v_max3_u32 v16, v16, v40, v41
    v_max3_u32 v16, v16, v42, v43
    v_max3_u32 v16, v16, v44, v45
    v_max3_u32 v16, v16, v46, v47
    v_max3_u32 v16, v16, v48, v49
    v_max3_u32 v16, v16, v50, v51
    v_max3_u32 v16, v16, v52, v53
    v_max3_u32 v16, v16, v54, v55
    v_max3_u32 v16, v16, v56, v57
    v_max3_u32 v16, v16, v58, v59
    v_max3_u32 v16, v16, v60, v61
    v_max3_u32 v16, v16, v62, v63
    v_cmp_eq_u32 vcc, -1, v16
    s_cbranch_vccz L_pollq_ok
    s_add_u32 s59, s59, 1
    s_cmp_lt_u32 s59, 200000
    s_cbranch_scc0 L_pollq_ok
    s_mov_b64 exec, vcc
    s_sleep 4
    s_branch L_pollq
L_pollq_ok:
    s_mov_b64 exec, -1
    v_add_f32 v32, v32, v40
    v_add_f32 v48, v48, v56
    v_add_f32 v33, v33, v41
    v_add_f32 v49, v49, v57
    v_add_f32 v34, v34, v42
    v_add_f32 v50, v50, v58
    v_add_f32 v35, v35, v43
    v_add_f32 v51, v51, v59
    v_add_f32 v36, v36, v44
    v_add_f32 v52, v52, v60
    v_add_f32 v37, v37, v45
    v_add_f32 v53, v53, v61
    v_add_f32 v38, v38, v46
    v_add_f32 v54, v54, v62
    v_add_f32 v39, v39, v47
    v_add_f32 v55, v55, v63
    v_add_f32 v32, v32, v48
    v_add_f32 v33, v33, v49
    v_add_f32 v34, v34, v50
    v_add_f32 v35, v35, v51
    v_add_f32 v36, v36, v52
    v_add_f32 v37, v37, v53
    v_add_f32 v38, v38, v54
    v_add_f32 v39, v39, v55
    v_cvt_pk_bf16_f32 v40, v32, v33
    v_cvt_pk_bf16_f32 v41, v34, v35
    v_cvt_pk_bf16_f32 v42, v36, v37
    v_cvt_pk_bf16_f32 v43, v38, v39
    v_lshlrev_b32 v16, 3, v0
    ds_write_b64 v16, v[40:41] offset:0
    ds_write_b64 v16, v[42:43] offset:512
    v_mov_b32 v99, 1
    s_waitcnt lgkmcnt(0)
    ds_write_b32 v98, v99
    s_mov_b32 s5, 0
L_pollf2:
    s_mov_b64 exec, 0xff
    global_load_dword v97, v96, s[36:37] sc1
    s_waitcnt vmcnt(0)
    v_cmp_ne_u32 vcc, 1, v97
    s_mov_b64 exec, -1
    s_cbranch_vccz L_pollf2_ok
    s_add_u32 s5, s5, 1
    s_cmp_lt_u32 s5, 200000
    s_cbranch_scc1 L_pollf2
L_pollf2_ok:
    v_add_u32 v19, 65536, v9
    s_mov_b32 s59, 0
L_pollall:
    global_load_dwordx4 v[32:35], v19, s[38:39] sc1
    s_waitcnt vmcnt(0)
    v_max_u32 v16, v32, v33
    v_max3_u32 v16, v16, v34, v35
    v_cmp_eq_u32 vcc, -1, v16
    s_cbranch_vccz L_pollall_ok
    s_add_u32 s59, s59, 1
    s_cmp_lt_u32 s59, 200000
    s_cbranch_scc0 L_pollall_ok
    s_mov_b64 exec, vcc
    s_sleep 16
    s_branch L_pollall
L_pollall_ok:
    s_mov_b64 exec, -1
    v_xor_b32 v32, v32, v21
    v_xor_b32 v33, v33, v21
    v_xor_b32 v34, v34, v21
    v_xor_b32 v35, v35, v21
    v_or_b32 v32, v32, v33
    v_or3_b32 v32, v32, v34, v35
    v_cmp_ne_u32 vcc, 0, v32
    s_lshl_b32 s4, s60, 3
    s_lshr_b64 s[4:5], vcc, s4
    s_and_b32 s4, s4, 0xff
    s_cselect_b32 s4, 0, 1
L_svcend:
    s_mov_b32 s63, s4
    s_andn2_b32 s8, s7, 4
    s_lshl_b32 s9, s6, 5
    s_add_u32 s8, s8, s9
    s_lshl_b32 s8, s8, 11
    s_and_b32 s9, s7, 4
    s_lshl_b32 s9, s9, 8
    s_add_u32 s8, s8, s9
    s_add_u32 s8, s8, 131072
    s_add_u32 s12, s38, s8
    s_addc_u32 s13, s39, 0
    s_mov_b32 s10, 0
    s_waitcnt lgkmcnt(0)
    s_mov_b32 s8, 0
    s_mov_b32 s9, 0
    s_load_dword s8, s[12:13], 0
    s_load_dword s9, s[12:13], 8192
    s_waitcnt lgkmcnt(1)
    s_sub_u32 s11, s9, s8
    s_waitcnt lgkmcnt(0)
    s_add_u32 s10, s10, s11
    s_mov_b32 s8, 0
    s_mov_b32 s9, 0
    s_load_dword s9, s[12:13], 8320
    s_load_dword s8, s[12:13], 128
    s_waitcnt lgkmcnt(1)
    s_sub_u32 s11, s9, s8
    s_waitcnt lgkmcnt(0)
    s_add_u32 s10, s10, s11
    s_cmp_eq_u32 s63, 1
    s_cbranch_scc0 L_novote
    s_lshl_b32 s8, s6, 7
    s_add_u32 s8, s8, 77824
    v_and_b32 v16, 31, v0
    v_lshl_add_u32 v16, v16, 2, s8
    s_lshl_b32 s9, s7, 2
    s_add_u32 s8, s8, s9
    v_mov_b32 v17, s8
    s_add_u32 s10, s10, 16
    v_mov_b32 v18, s10
    s_mov_b64 exec, 1
    global_store_dword v17, v18, s[38:39]
    s_mov_b64 exec, -1
    v_mov_b32 v24, 2304
    s_mov_b32 s5, 0
L_waitv:
    ds_read_b32 v25, v24 offset:20
    s_waitcnt lgkmcnt(0)
    v_cmp_ne_u32 vcc, 0, v25
    s_cbranch_vccnz L_waitv_ok
    s_add_u32 s5, s5, 1
    s_cmp_lt_u32 s5, 12800000
    s_cbranch_scc0 L_waitv_ok
    s_sleep 1
    s_branch L_waitv
L_waitv_ok:
    global_load_dword v18, v16, s[38:39] sc1
    s_waitcnt vmcnt(0)
    v_cmp_lt_i32 vcc, 16, v18
    s_nop 0
    s_bcnt1_i32_b64 s10, vcc
    v_cmp_gt_u32 vcc, 16, v18
    s_nop 0
    s_bcnt1_i32_b64 s8, vcc
    s_sub_u32 s10, s10, s8
L_novote:
    s_cmp_lt_i32 s10, 0
    s_cselect_b32 s10, 0x2000, 0
    v_mov_b32 v99, s10
    ds_write_b32 v98, v99 offset:16
    s_add_u32 s61, s6, 0
    s_and_b32 s61, s61, 7
    s_bfe_u32 s13, s7, 0x10003
    s_lshl_b32 s4, s61, 1
    s_add_u32 s13, s13, s4
    s_and_b32 s14, s7, 7
    s_mul_i32 s15, s6, 14
    s_add_u32 s15, s15, s7
    v_mov_b32 v99, s63
    ds_write_b32 v98, v99 offset:4
    s_lshl_b32 s4, s6, 7
    s_add_u32 s4, s4, 69632
    v_and_b32 v16, 31, v0
    v_lshl_add_u32 v16, v16, 2, s4
    s_lshl_b32 s5, s7, 2
    s_add_u32 s4, s4, s5
    v_mov_b32 v17, s4
    v_mov_b32 v18, 0
    s_and_b32 s4, s7, 0
    s_mul_i32 s4, s4, 114688
    s_mul_i32 s5, s6, 448
    s_andn2_b32 s5, s5, 127
    s_add_u32 s4, s4, s5
    v_lshrrev_b32 v21, 5, v0
    v_mul_u32_u24 v21, 3584, v21
    v_and_b32 v22, 31, v0
    v_lshl_add_u32 v21, v22, 4, v21
    v_add_u32 v21, s4, v21
    s_lshl_b32 s4, s6, 7
    s_add_u32 s4, s4, 73728
    v_mov_b32 v26, s4
    v_mov_b32 v27, 1
    s_lshl_b32 s4, s7, 1
    s_sub_u32 s4, s4, 1
    v_mov_b32 v28, 0
    v_lshrrev_b32 v22, 1, v0
    v_mul_u32_u24 v22, 3584, v22
    v_and_b32 v23, 1, v0
    v_lshl_add_u32 v22, v23, 4, v22
    s_lshl_b32 s4, s15, 5
    v_add_u32 v22, s4, v22
    s_lshl_b32 s4, s15, 14
    v_add_u32 v23, s4, v9
    s_waitcnt lgkmcnt(0)
    s_barrier
    s_barrier
    s_barrier
    s_cmp_eq_u32 s63, 1
    s_cbranch_scc0 L_nosig
    s_mov_b64 exec, 1
    global_store_dword v17, v18, s[38:39]
    s_cmp_lt_u32 s7, 16
    s_cbranch_scc0 L_norank
    global_atomic_add v28, v26, v27, s[38:39] sc0 sc1
L_norank:
    s_mov_b64 exec, -1
L_nosig:
    s_cmp_eq_u32 s63, 1
    s_cbranch_scc0 L_nog1
    global_load_dword v19, v16, s[38:39] sc1
L_nog1:
    s_barrier
    s_cmp_eq_u32 s63, 1
    s_cbranch_scc0 L_gok
    s_mov_b32 s5, 0
L_pollg:
    s_waitcnt vmcnt(0)
    v_cmp_eq_u32 vcc, -1, v19
    s_nop 0
    s_bcnt1_i32_b32 s4, vcc_lo
    s_cmp_le_u32 s4, 16
    s_cbranch_scc1 L_gok
    s_add_u32 s5, s5, 1
    s_cmp_lt_u32 s5, 200000
    s_cbranch_scc0 L_gok
    s_sleep 2
    global_load_dword v19, v16, s[38:39] sc1
    s_branch L_pollg
L_gok:
    s_cmp_lt_u32 s7, 16
    s_cbranch_scc0 L_nopre
    s_waitcnt vmcnt(0)
    v_readfirstlane_b32 s8, v28
    s_nop 0
    s_add_u32 s8, s8, 1
    s_mul_i32 s9, s8, 3
    s_lshl_b32 s4, s8, 1
    s_add_u32 s4, s4, 8
    s_cmp_lt_u32 s8, 8
    s_cselect_b32 s9, s9, s4
    s_cselect_b32 s5, 24, 16
    s_cmp_lt_u32 s8, 12
    s_cselect_b32 s5, s5, 0
    s_lshl_b32 s4, s7, 1
    s_cmp_eq_u32 s63, 1
    s_cselect_b32 s9, s9, s4
    s_cselect_b32 s5, s5, 16
    s_mul_i32 s9, s9, 57344
    v_add_u32 v21, s9, v21
    s_cmp_eq_u32 s5, 0
    s_cbranch_scc1 L_nopre
L_wpre:
    global_load_dwordx4 v[32:35], v21, s[28:29]
    global_load_dwordx4 v[32:35], v21, s[30:31]
    v_add_u32 v21, 7168, v21
    s_sub_u32 s5, s5, 1
    s_cmp_lg_u32 s5, 0
    s_cbranch_scc1 L_wpre
    s_waitcnt vmcnt(30)
L_nopre:
    s_cmp_lt_u32 s7, 14
    s_cbranch_scc0 L_nogu
    s_mov_b32 s5, 16
    s_mov_b32 m0, 8704
L_wgu:
    s_nop 0
    global_load_lds_dwordx4 v22, s[28:29]
    s_add_u32 m0, m0, 16384
    s_nop 0
    global_load_lds_dwordx4 v22, s[30:31]
    v_add_u32 v22, 114688, v22
    s_sub_u32 m0, m0, 15360
    s_sub_u32 s5, s5, 1
    s_cmp_lg_u32 s5, 0
    s_cbranch_scc1 L_wgu
L_nogu:
    s_cmp_lt_u32 s7, 14
    s_cbranch_scc0 L_wdone
    s_barrier
L_wdone:
    s_waitcnt vmcnt(0)
    s_barrier
    s_endpgm
L_end:
    s_endpgm
L_codeend:
.section .rodata,"a"
.p2align 6
.amdhsa_kernel sequential_preLN__gqa_block_cached__glu_gated_geglu__decode_kernel
  .amdhsa_next_free_vgpr 168
  .amdhsa_next_free_sgpr 96
  .amdhsa_accum_offset 168
  .amdhsa_group_segment_fixed_size 0
  .amdhsa_kernarg_size 96
  .amdhsa_user_sgpr_count 2
  .amdhsa_user_sgpr_kernarg_segment_ptr 1
  .amdhsa_system_sgpr_workgroup_id_x 1
  .amdhsa_float_denorm_mode_32 3
.end_amdhsa_kernel
```
